```python
import torch

def _softmax(x, axis=-1):
    return torch.softmax(x, dim=axis)
def _gelu(x):
    return torch.nn.functional.gelu(x, approximate="tanh")
def _silu(x):
    return torch.nn.functional.silu(x)
def _sigmoid(x):
    return torch.sigmoid(x)
def _layernorm(x, axis=-1, eps=1e-5):
    m = x.mean(dim=axis, keepdim=True)
    v = x.var(dim=axis, keepdim=True, unbiased=False)
    return (x - m) / torch.sqrt(v + eps)
def _scatter_add(tgt, idx, src, axis=0):
    return tgt.clone().index_add_(axis, idx, src)
def _segment_sum(src, seg, n):
    out = torch.zeros((n,) + src.shape[1:], dtype=src.dtype)
    return out.index_add_(0, seg, src)
def _pad(x, pw):
    flat = tuple(v for pair in reversed(pw) for v in pair)
    return torch.nn.functional.pad(x, flat)

kernel_name = 'gated_mix__ssm_conv_s4d__mixer_token_mlp__prompt'

def setup_inputs():

    _w = (lambda a: (lambda t: t.to(torch.bfloat16) if t.is_floating_point() else t)(torch.as_tensor(a)))
    def _A_setup():
        Bsz, L, D, N = 1, 2048, 576, 128
        return {
            "u": _w((lambda *s: torch.randn(*s, dtype=torch.bfloat16) * 0.05)(Bsz, L, D)),
            "log_A_real": _w((lambda *s: torch.randn(*s, dtype=torch.bfloat16) * 3.2)(D, N) * 0.5),
            "A_imag": _w((lambda *s: torch.randn(*s, dtype=torch.bfloat16) * 0.05)(D, N) * 3.14),
            "C_real": _w((lambda *s: torch.randn(*s, dtype=torch.bfloat16) * 0.1)(D, N) / N ** 0.5),
            "C_imag": _w((lambda *s: torch.randn(*s, dtype=torch.bfloat16) * 0.1)(D, N) / N ** 0.5),
            "log_dt": _w((lambda *s: torch.randn(*s, dtype=torch.bfloat16) * 0.05)(D) * 0.5 - 4.0),
            "D_skip": _w((lambda *s: torch.randn(*s, dtype=torch.bfloat16) * 0.05)(D)),
        }
    _A_in = _A_setup()

    def _B_setup():
        B, S, D, F = 1, 2048, 576, 4608
        return {
            "x": _w((lambda *s: torch.randn(*s, dtype=torch.bfloat16) * 0.05)(B, S, D)),
            "w1": _w((lambda *s: torch.randn(*s, dtype=torch.bfloat16) * 0.2)(S, F) * (S ** -0.5)),
            "b1": _w((lambda *s: torch.randn(*s, dtype=torch.bfloat16) * 3.2)(F) * 0.02),
            "w2": _w((lambda *s: torch.randn(*s, dtype=torch.bfloat16) * 0.05)(F, S) * (F ** -0.5)),
            "b2": _w((lambda *s: torch.randn(*s, dtype=torch.bfloat16) * 0.1)(S) * 0.02),
        }
    _B_in = _B_setup()

    return {
        "A_u": _A_in["u"],
        "A_log_A_real": _A_in["log_A_real"],
        "A_A_imag": _A_in["A_imag"],
        "A_C_real": _A_in["C_real"],
        "A_C_imag": _A_in["C_imag"],
        "A_log_dt": _A_in["log_dt"],
        "A_D_skip": _A_in["D_skip"],
        "B_x": _B_in["x"],
        "B_w1": _B_in["w1"],
        "B_b1": _B_in["b1"],
        "B_w2": _B_in["w2"],
        "B_b2": _B_in["b2"],
        "gate_w": _w((lambda *s: torch.randn(*s, dtype=torch.bfloat16) * 0.05)(576) * 16.0),
    }

def reference(A_u, A_log_A_real, A_A_imag, A_C_real, A_C_imag, A_log_dt, A_D_skip, B_x, B_w1, B_b1, B_w2, B_b2, gate_w):
    def _A_ref(u, log_A_real, A_imag, C_real, C_imag, log_dt, D_skip):
        L = u.shape[1]
        dt = torch.exp(log_dt)
        A = -torch.exp(log_A_real) + 1j * A_imag
        C = (C_real + 1j * C_imag) * dt[:, None]
        pos = (lambda x, dt: x.to(dt))(torch.arange(L), log_dt.dtype)
        P = torch.exp((A * dt[:, None])[:, :, None] * pos[None, None, :])
        K = 2.0 * torch.einsum("dn,dnl->dl", C, P).real
        L2 = 2 * L
        u_t = (lambda x, *d: x.permute(*d))(u, 0, 2, 1)
        Kf = (lambda x, *a, **k: torch.fft.rfft(x.float(), *a, **k))(K, L2)
        Uf = (lambda x, *a, **k: torch.fft.rfft(x.float(), *a, **k))(u_t, L2)
        y = (lambda x, *a, **k: torch.fft.irfft(x, *a, **k).to(torch.bfloat16))(Uf * Kf[None, :, :], L2)[:, :, :L]
        y = (lambda x, *d: x.permute(*d))(y, 0, 2, 1)
        return y + u * D_skip[None, None, :]

    def _B_ref(x, w1, b1, w2, b2):
        B, S, D = x.shape
        h = _layernorm(x, axis=-1)
        u = torch.einsum("bsd,sf->bdf", h, w1) + b1
        u = _gelu(u)
        y = torch.einsum("bdf,fs->bds", u, w2) + b2
        return (lambda x, *d: x.permute(*d))(y, 0, 2, 1)

    x = A_u
    g = _sigmoid((x * gate_w).sum(-1, keepdims=True))
    a = _A_ref(x, A_log_A_real, A_A_imag, A_C_real, A_C_imag, A_log_dt, A_D_skip)
    b = _B_ref(x, B_w1, B_b1, B_w2, B_b2)
    return g * a + (1 - g) * b
```

```asm
; @launch kernel=prep_kernel grid=(256,1,1) block=(256,1,1) lds=40960
; @launch kernel=gemm1_kernel grid=(792,1,1) block=(512,1,1) lds=71680
; @launch kernel=gated_mix__ssm_conv_s4d__mixer_token_mlp__prompt_kernel grid=(256,1,1) block=(512,1,1) lds=92160
.amdgcn_target "amdgcn-amd-amdhsa--gfx950"
.text
.globl prep_kernel
.p2align 8
.type prep_kernel,@function
prep_kernel:
    s_cmp_lt_u32 s2, 64
    s_cbranch_scc1 PREP_LN
    s_cmp_lt_u32 s2, 128
    s_cbranch_scc1 PREP_GATE
    s_cmp_lt_u32 s2, 256
    s_cbranch_scc0 PREP_END
    s_load_dwordx2 s[52:53], s[0:1], 64
    s_sub_u32 s28, s2, 128
    s_mul_i32 s54, s28, 147456
    v_lshlrev_b32 v124, 4, v0
    v_add_u32 v124, s54, v124
    s_waitcnt lgkmcnt(0)
    s_mov_b32 s60, s52
    s_and_b32 s61, s53, 0xffff
    s_mov_b32 s62, 18874368
    s_mov_b32 s63, 0x00020000
    s_mov_b32 s55, 0
PF1_LOOP:
    buffer_load_dwordx4 v[64:67], v124, s[60:63], s55 offen
    s_add_u32 s55, s55, 4096
    buffer_load_dwordx4 v[68:71], v124, s[60:63], s55 offen
    s_add_u32 s55, s55, 4096
    buffer_load_dwordx4 v[72:75], v124, s[60:63], s55 offen
    s_add_u32 s55, s55, 4096
    buffer_load_dwordx4 v[76:79], v124, s[60:63], s55 offen
    s_add_u32 s55, s55, 4096
    buffer_load_dwordx4 v[80:83], v124, s[60:63], s55 offen
    s_add_u32 s55, s55, 4096
    buffer_load_dwordx4 v[84:87], v124, s[60:63], s55 offen
    s_add_u32 s55, s55, 4096
    buffer_load_dwordx4 v[88:91], v124, s[60:63], s55 offen
    s_add_u32 s55, s55, 4096
    buffer_load_dwordx4 v[92:95], v124, s[60:63], s55 offen
    s_add_u32 s55, s55, 4096
    buffer_load_dwordx4 v[96:99], v124, s[60:63], s55 offen
    s_add_u32 s55, s55, 4096
    buffer_load_dwordx4 v[100:103], v124, s[60:63], s55 offen
    s_add_u32 s55, s55, 4096
    buffer_load_dwordx4 v[104:107], v124, s[60:63], s55 offen
    s_add_u32 s55, s55, 4096
    buffer_load_dwordx4 v[108:111], v124, s[60:63], s55 offen
    s_add_u32 s55, s55, 4096
    s_waitcnt vmcnt(6)
    s_cmp_lt_u32 s55, 147456
    s_cbranch_scc1 PF1_LOOP
    s_waitcnt vmcnt(0)
PREP_END:
    s_endpgm
PREP_LN:
    s_load_dwordx2 s[4:5], s[0:1], 0
    s_load_dwordx2 s[6:7], s[0:1], 120
    s_mov_b32 s20, s2
    v_and_b32 v1, 63, v0
    v_lshrrev_b32 v2, 3, v0
    v_and_b32 v3, 7, v0
    s_lshl_b32 s21, s20, 5
    v_add_u32 v4, s21, v2
    v_mul_u32_u24 v4, 1152, v4
    v_lshl_add_u32 v4, v3, 4, v4
    s_waitcnt lgkmcnt(0)
    s_mov_b32 s8, s4
    s_and_b32 s9, s5, 0xffff
    s_mov_b32 s10, 2359296
    s_mov_b32 s11, 0x00020000
    s_add_u32 s24, s6, 0
    s_addc_u32 s25, s7, 0
    s_and_b32 s25, s25, 0xffff
    s_mov_b32 s26, 2359296
    s_mov_b32 s27, 0x00020000
    buffer_load_dwordx4 v[16:19], v4, s[8:11], 0 offen offset:0
    buffer_load_dwordx4 v[20:23], v4, s[8:11], 0 offen offset:128
    buffer_load_dwordx4 v[24:27], v4, s[8:11], 0 offen offset:256
    buffer_load_dwordx4 v[28:31], v4, s[8:11], 0 offen offset:384
    buffer_load_dwordx4 v[32:35], v4, s[8:11], 0 offen offset:512
    buffer_load_dwordx4 v[36:39], v4, s[8:11], 0 offen offset:640
    buffer_load_dwordx4 v[40:43], v4, s[8:11], 0 offen offset:768
    buffer_load_dwordx4 v[44:47], v4, s[8:11], 0 offen offset:896
    buffer_load_dwordx4 v[48:51], v4, s[8:11], 0 offen offset:1024
    s_mov_b32 s30, 0xffff0000
    v_mov_b32 v8, 0
    s_waitcnt vmcnt(0)
    v_lshlrev_b32 v9, 16, v16
    v_and_b32 v10, s30, v16
    v_add_f32 v8, v8, v9
    v_add_f32 v8, v8, v10
    v_lshlrev_b32 v9, 16, v17
    v_and_b32 v10, s30, v17
    v_add_f32 v8, v8, v9
    v_add_f32 v8, v8, v10
    v_lshlrev_b32 v9, 16, v18
    v_and_b32 v10, s30, v18
    v_add_f32 v8, v8, v9
    v_add_f32 v8, v8, v10
    v_lshlrev_b32 v9, 16, v19
    v_and_b32 v10, s30, v19
    v_add_f32 v8, v8, v9
    v_add_f32 v8, v8, v10
    v_lshlrev_b32 v9, 16, v20
    v_and_b32 v10, s30, v20
    v_add_f32 v8, v8, v9
    v_add_f32 v8, v8, v10
    v_lshlrev_b32 v9, 16, v21
    v_and_b32 v10, s30, v21
    v_add_f32 v8, v8, v9
    v_add_f32 v8, v8, v10
    v_lshlrev_b32 v9, 16, v22
    v_and_b32 v10, s30, v22
    v_add_f32 v8, v8, v9
    v_add_f32 v8, v8, v10
    v_lshlrev_b32 v9, 16, v23
    v_and_b32 v10, s30, v23
    v_add_f32 v8, v8, v9
    v_add_f32 v8, v8, v10
    v_lshlrev_b32 v9, 16, v24
    v_and_b32 v10, s30, v24
    v_add_f32 v8, v8, v9
    v_add_f32 v8, v8, v10
    v_lshlrev_b32 v9, 16, v25
    v_and_b32 v10, s30, v25
    v_add_f32 v8, v8, v9
    v_add_f32 v8, v8, v10
    v_lshlrev_b32 v9, 16, v26
    v_and_b32 v10, s30, v26
    v_add_f32 v8, v8, v9
    v_add_f32 v8, v8, v10
    v_lshlrev_b32 v9, 16, v27
    v_and_b32 v10, s30, v27
    v_add_f32 v8, v8, v9
    v_add_f32 v8, v8, v10
    v_lshlrev_b32 v9, 16, v28
    v_and_b32 v10, s30, v28
    v_add_f32 v8, v8, v9
    v_add_f32 v8, v8, v10
    v_lshlrev_b32 v9, 16, v29
    v_and_b32 v10, s30, v29
    v_add_f32 v8, v8, v9
    v_add_f32 v8, v8, v10
    v_lshlrev_b32 v9, 16, v30
    v_and_b32 v10, s30, v30
    v_add_f32 v8, v8, v9
    v_add_f32 v8, v8, v10
    v_lshlrev_b32 v9, 16, v31
    v_and_b32 v10, s30, v31
    v_add_f32 v8, v8, v9
    v_add_f32 v8, v8, v10
    v_lshlrev_b32 v9, 16, v32
    v_and_b32 v10, s30, v32
    v_add_f32 v8, v8, v9
    v_add_f32 v8, v8, v10
    v_lshlrev_b32 v9, 16, v33
    v_and_b32 v10, s30, v33
    v_add_f32 v8, v8, v9
    v_add_f32 v8, v8, v10
    v_lshlrev_b32 v9, 16, v34
    v_and_b32 v10, s30, v34
    v_add_f32 v8, v8, v9
    v_add_f32 v8, v8, v10
    v_lshlrev_b32 v9, 16, v35
    v_and_b32 v10, s30, v35
    v_add_f32 v8, v8, v9
    v_add_f32 v8, v8, v10
    v_lshlrev_b32 v9, 16, v36
    v_and_b32 v10, s30, v36
    v_add_f32 v8, v8, v9
    v_add_f32 v8, v8, v10
    v_lshlrev_b32 v9, 16, v37
    v_and_b32 v10, s30, v37
    v_add_f32 v8, v8, v9
    v_add_f32 v8, v8, v10
    v_lshlrev_b32 v9, 16, v38
    v_and_b32 v10, s30, v38
    v_add_f32 v8, v8, v9
    v_add_f32 v8, v8, v10
    v_lshlrev_b32 v9, 16, v39
    v_and_b32 v10, s30, v39
    v_add_f32 v8, v8, v9
    v_add_f32 v8, v8, v10
    v_lshlrev_b32 v9, 16, v40
    v_and_b32 v10, s30, v40
    v_add_f32 v8, v8, v9
    v_add_f32 v8, v8, v10
    v_lshlrev_b32 v9, 16, v41
    v_and_b32 v10, s30, v41
    v_add_f32 v8, v8, v9
    v_add_f32 v8, v8, v10
    v_lshlrev_b32 v9, 16, v42
    v_and_b32 v10, s30, v42
    v_add_f32 v8, v8, v9
    v_add_f32 v8, v8, v10
    v_lshlrev_b32 v9, 16, v43
    v_and_b32 v10, s30, v43
    v_add_f32 v8, v8, v9
    v_add_f32 v8, v8, v10
    v_lshlrev_b32 v9, 16, v44
    v_and_b32 v10, s30, v44
    v_add_f32 v8, v8, v9
    v_add_f32 v8, v8, v10
    v_lshlrev_b32 v9, 16, v45
    v_and_b32 v10, s30, v45
    v_add_f32 v8, v8, v9
    v_add_f32 v8, v8, v10
    v_lshlrev_b32 v9, 16, v46
    v_and_b32 v10, s30, v46
    v_add_f32 v8, v8, v9
    v_add_f32 v8, v8, v10
    v_lshlrev_b32 v9, 16, v47
    v_and_b32 v10, s30, v47
    v_add_f32 v8, v8, v9
    v_add_f32 v8, v8, v10
    v_lshlrev_b32 v9, 16, v48
    v_and_b32 v10, s30, v48
    v_add_f32 v8, v8, v9
    v_add_f32 v8, v8, v10
    v_lshlrev_b32 v9, 16, v49
    v_and_b32 v10, s30, v49
    v_add_f32 v8, v8, v9
    v_add_f32 v8, v8, v10
    v_lshlrev_b32 v9, 16, v50
    v_and_b32 v10, s30, v50
    v_add_f32 v8, v8, v9
    v_add_f32 v8, v8, v10
    v_lshlrev_b32 v9, 16, v51
    v_and_b32 v10, s30, v51
    v_add_f32 v8, v8, v9
    v_add_f32 v8, v8, v10
    s_nop 1
    v_add_f32_dpp v8, v8, v8 quad_perm:[1,0,3,2] row_mask:0xf bank_mask:0xf
    s_nop 1
    v_add_f32_dpp v8, v8, v8 quad_perm:[2,3,0,1] row_mask:0xf bank_mask:0xf
    s_nop 1
    v_add_f32_dpp v8, v8, v8 row_half_mirror row_mask:0xf bank_mask:0xf
    s_mov_b32 s31, 0x3ae38e39
    v_mul_f32 v8, s31, v8
    v_mov_b32 v11, 0
    v_lshlrev_b32 v9, 16, v16
    v_and_b32 v10, s30, v16
    v_sub_f32 v9, v9, v8
    v_sub_f32 v10, v10, v8
    v_fmac_f32 v11, v9, v9
    v_fmac_f32 v11, v10, v10
    v_lshlrev_b32 v9, 16, v17
    v_and_b32 v10, s30, v17
    v_sub_f32 v9, v9, v8
    v_sub_f32 v10, v10, v8
    v_fmac_f32 v11, v9, v9
    v_fmac_f32 v11, v10, v10
    v_lshlrev_b32 v9, 16, v18
    v_and_b32 v10, s30, v18
    v_sub_f32 v9, v9, v8
    v_sub_f32 v10, v10, v8
    v_fmac_f32 v11, v9, v9
    v_fmac_f32 v11, v10, v10
    v_lshlrev_b32 v9, 16, v19
    v_and_b32 v10, s30, v19
    v_sub_f32 v9, v9, v8
    v_sub_f32 v10, v10, v8
    v_fmac_f32 v11, v9, v9
    v_fmac_f32 v11, v10, v10
    v_lshlrev_b32 v9, 16, v20
    v_and_b32 v10, s30, v20
    v_sub_f32 v9, v9, v8
    v_sub_f32 v10, v10, v8
    v_fmac_f32 v11, v9, v9
    v_fmac_f32 v11, v10, v10
    v_lshlrev_b32 v9, 16, v21
    v_and_b32 v10, s30, v21
    v_sub_f32 v9, v9, v8
    v_sub_f32 v10, v10, v8
    v_fmac_f32 v11, v9, v9
    v_fmac_f32 v11, v10, v10
    v_lshlrev_b32 v9, 16, v22
    v_and_b32 v10, s30, v22
    v_sub_f32 v9, v9, v8
    v_sub_f32 v10, v10, v8
    v_fmac_f32 v11, v9, v9
    v_fmac_f32 v11, v10, v10
    v_lshlrev_b32 v9, 16, v23
    v_and_b32 v10, s30, v23
    v_sub_f32 v9, v9, v8
    v_sub_f32 v10, v10, v8
    v_fmac_f32 v11, v9, v9
    v_fmac_f32 v11, v10, v10
    v_lshlrev_b32 v9, 16, v24
    v_and_b32 v10, s30, v24
    v_sub_f32 v9, v9, v8
    v_sub_f32 v10, v10, v8
    v_fmac_f32 v11, v9, v9
    v_fmac_f32 v11, v10, v10
    v_lshlrev_b32 v9, 16, v25
    v_and_b32 v10, s30, v25
    v_sub_f32 v9, v9, v8
    v_sub_f32 v10, v10, v8
    v_fmac_f32 v11, v9, v9
    v_fmac_f32 v11, v10, v10
    v_lshlrev_b32 v9, 16, v26
    v_and_b32 v10, s30, v26
    v_sub_f32 v9, v9, v8
    v_sub_f32 v10, v10, v8
    v_fmac_f32 v11, v9, v9
    v_fmac_f32 v11, v10, v10
    v_lshlrev_b32 v9, 16, v27
    v_and_b32 v10, s30, v27
    v_sub_f32 v9, v9, v8
    v_sub_f32 v10, v10, v8
    v_fmac_f32 v11, v9, v9
    v_fmac_f32 v11, v10, v10
    v_lshlrev_b32 v9, 16, v28
    v_and_b32 v10, s30, v28
    v_sub_f32 v9, v9, v8
    v_sub_f32 v10, v10, v8
    v_fmac_f32 v11, v9, v9
    v_fmac_f32 v11, v10, v10
    v_lshlrev_b32 v9, 16, v29
    v_and_b32 v10, s30, v29
    v_sub_f32 v9, v9, v8
    v_sub_f32 v10, v10, v8
    v_fmac_f32 v11, v9, v9
    v_fmac_f32 v11, v10, v10
    v_lshlrev_b32 v9, 16, v30
    v_and_b32 v10, s30, v30
    v_sub_f32 v9, v9, v8
    v_sub_f32 v10, v10, v8
    v_fmac_f32 v11, v9, v9
    v_fmac_f32 v11, v10, v10
    v_lshlrev_b32 v9, 16, v31
    v_and_b32 v10, s30, v31
    v_sub_f32 v9, v9, v8
    v_sub_f32 v10, v10, v8
    v_fmac_f32 v11, v9, v9
    v_fmac_f32 v11, v10, v10
    v_lshlrev_b32 v9, 16, v32
    v_and_b32 v10, s30, v32
    v_sub_f32 v9, v9, v8
    v_sub_f32 v10, v10, v8
    v_fmac_f32 v11, v9, v9
    v_fmac_f32 v11, v10, v10
    v_lshlrev_b32 v9, 16, v33
    v_and_b32 v10, s30, v33
    v_sub_f32 v9, v9, v8
    v_sub_f32 v10, v10, v8
    v_fmac_f32 v11, v9, v9
    v_fmac_f32 v11, v10, v10
    v_lshlrev_b32 v9, 16, v34
    v_and_b32 v10, s30, v34
    v_sub_f32 v9, v9, v8
    v_sub_f32 v10, v10, v8
    v_fmac_f32 v11, v9, v9
    v_fmac_f32 v11, v10, v10
    v_lshlrev_b32 v9, 16, v35
    v_and_b32 v10, s30, v35
    v_sub_f32 v9, v9, v8
    v_sub_f32 v10, v10, v8
    v_fmac_f32 v11, v9, v9
    v_fmac_f32 v11, v10, v10
    v_lshlrev_b32 v9, 16, v36
    v_and_b32 v10, s30, v36
    v_sub_f32 v9, v9, v8
    v_sub_f32 v10, v10, v8
    v_fmac_f32 v11, v9, v9
    v_fmac_f32 v11, v10, v10
    v_lshlrev_b32 v9, 16, v37
    v_and_b32 v10, s30, v37
    v_sub_f32 v9, v9, v8
    v_sub_f32 v10, v10, v8
    v_fmac_f32 v11, v9, v9
    v_fmac_f32 v11, v10, v10
    v_lshlrev_b32 v9, 16, v38
    v_and_b32 v10, s30, v38
    v_sub_f32 v9, v9, v8
    v_sub_f32 v10, v10, v8
    v_fmac_f32 v11, v9, v9
    v_fmac_f32 v11, v10, v10
    v_lshlrev_b32 v9, 16, v39
    v_and_b32 v10, s30, v39
    v_sub_f32 v9, v9, v8
    v_sub_f32 v10, v10, v8
    v_fmac_f32 v11, v9, v9
    v_fmac_f32 v11, v10, v10
    v_lshlrev_b32 v9, 16, v40
    v_and_b32 v10, s30, v40
    v_sub_f32 v9, v9, v8
    v_sub_f32 v10, v10, v8
    v_fmac_f32 v11, v9, v9
    v_fmac_f32 v11, v10, v10
    v_lshlrev_b32 v9, 16, v41
    v_and_b32 v10, s30, v41
    v_sub_f32 v9, v9, v8
    v_sub_f32 v10, v10, v8
    v_fmac_f32 v11, v9, v9
    v_fmac_f32 v11, v10, v10
    v_lshlrev_b32 v9, 16, v42
    v_and_b32 v10, s30, v42
    v_sub_f32 v9, v9, v8
    v_sub_f32 v10, v10, v8
    v_fmac_f32 v11, v9, v9
    v_fmac_f32 v11, v10, v10
    v_lshlrev_b32 v9, 16, v43
    v_and_b32 v10, s30, v43
    v_sub_f32 v9, v9, v8
    v_sub_f32 v10, v10, v8
    v_fmac_f32 v11, v9, v9
    v_fmac_f32 v11, v10, v10
    v_lshlrev_b32 v9, 16, v44
    v_and_b32 v10, s30, v44
    v_sub_f32 v9, v9, v8
    v_sub_f32 v10, v10, v8
    v_fmac_f32 v11, v9, v9
    v_fmac_f32 v11, v10, v10
    v_lshlrev_b32 v9, 16, v45
    v_and_b32 v10, s30, v45
    v_sub_f32 v9, v9, v8
    v_sub_f32 v10, v10, v8
    v_fmac_f32 v11, v9, v9
    v_fmac_f32 v11, v10, v10
    v_lshlrev_b32 v9, 16, v46
    v_and_b32 v10, s30, v46
    v_sub_f32 v9, v9, v8
    v_sub_f32 v10, v10, v8
    v_fmac_f32 v11, v9, v9
    v_fmac_f32 v11, v10, v10
    v_lshlrev_b32 v9, 16, v47
    v_and_b32 v10, s30, v47
    v_sub_f32 v9, v9, v8
    v_sub_f32 v10, v10, v8
    v_fmac_f32 v11, v9, v9
    v_fmac_f32 v11, v10, v10
    v_lshlrev_b32 v9, 16, v48
    v_and_b32 v10, s30, v48
    v_sub_f32 v9, v9, v8
    v_sub_f32 v10, v10, v8
    v_fmac_f32 v11, v9, v9
    v_fmac_f32 v11, v10, v10
    v_lshlrev_b32 v9, 16, v49
    v_and_b32 v10, s30, v49
    v_sub_f32 v9, v9, v8
    v_sub_f32 v10, v10, v8
    v_fmac_f32 v11, v9, v9
    v_fmac_f32 v11, v10, v10
    v_lshlrev_b32 v9, 16, v50
    v_and_b32 v10, s30, v50
    v_sub_f32 v9, v9, v8
    v_sub_f32 v10, v10, v8
    v_fmac_f32 v11, v9, v9
    v_fmac_f32 v11, v10, v10
    v_lshlrev_b32 v9, 16, v51
    v_and_b32 v10, s30, v51
    v_sub_f32 v9, v9, v8
    v_sub_f32 v10, v10, v8
    v_fmac_f32 v11, v9, v9
    v_fmac_f32 v11, v10, v10
    s_nop 1
    v_add_f32_dpp v11, v11, v11 quad_perm:[1,0,3,2] row_mask:0xf bank_mask:0xf
    s_nop 1
    v_add_f32_dpp v11, v11, v11 quad_perm:[2,3,0,1] row_mask:0xf bank_mask:0xf
    s_nop 1
    v_add_f32_dpp v11, v11, v11 row_half_mirror row_mask:0xf bank_mask:0xf
    v_mul_f32 v11, s31, v11
    v_cvt_pk_bf16_f32 v12, v8, v11
    v_lshlrev_b32 v8, 16, v12
    v_and_b32 v11, s30, v12
    v_add_f32 v11, 0x3727c5ac, v11
    v_cvt_pk_bf16_f32 v12, v11, v11
    v_lshlrev_b32 v11, 16, v12
    v_sqrt_f32 v11, v11
    s_nop 0
    v_cvt_pk_bf16_f32 v12, v11, v11
    v_lshlrev_b32 v11, 16, v12
    v_rcp_f32 v13, v11
    s_nop 0
    v_lshlrev_b32 v9, 16, v16
    v_and_b32 v10, s30, v16
    v_sub_f32 v9, v9, v8
    v_sub_f32 v10, v10, v8
    v_cvt_pk_bf16_f32 v12, v9, v10
    v_lshlrev_b32 v9, 16, v12
    v_and_b32 v10, s30, v12
    v_mul_f32 v14, v9, v13
    v_mul_f32 v15, v10, v13
    v_fma_f32 v9, -v14, v11, v9
    v_fma_f32 v10, -v15, v11, v10
    v_fmac_f32 v14, v9, v13
    v_fmac_f32 v15, v10, v13
    v_cvt_pk_bf16_f32 v16, v14, v15
    v_lshlrev_b32 v9, 16, v17
    v_and_b32 v10, s30, v17
    v_sub_f32 v9, v9, v8
    v_sub_f32 v10, v10, v8
    v_cvt_pk_bf16_f32 v12, v9, v10
    v_lshlrev_b32 v9, 16, v12
    v_and_b32 v10, s30, v12
    v_mul_f32 v14, v9, v13
    v_mul_f32 v15, v10, v13
    v_fma_f32 v9, -v14, v11, v9
    v_fma_f32 v10, -v15, v11, v10
    v_fmac_f32 v14, v9, v13
    v_fmac_f32 v15, v10, v13
    v_cvt_pk_bf16_f32 v17, v14, v15
    v_lshlrev_b32 v9, 16, v18
    v_and_b32 v10, s30, v18
    v_sub_f32 v9, v9, v8
    v_sub_f32 v10, v10, v8
    v_cvt_pk_bf16_f32 v12, v9, v10
    v_lshlrev_b32 v9, 16, v12
    v_and_b32 v10, s30, v12
    v_mul_f32 v14, v9, v13
    v_mul_f32 v15, v10, v13
    v_fma_f32 v9, -v14, v11, v9
    v_fma_f32 v10, -v15, v11, v10
    v_fmac_f32 v14, v9, v13
    v_fmac_f32 v15, v10, v13
    v_cvt_pk_bf16_f32 v18, v14, v15
    v_lshlrev_b32 v9, 16, v19
    v_and_b32 v10, s30, v19
    v_sub_f32 v9, v9, v8
    v_sub_f32 v10, v10, v8
    v_cvt_pk_bf16_f32 v12, v9, v10
    v_lshlrev_b32 v9, 16, v12
    v_and_b32 v10, s30, v12
    v_mul_f32 v14, v9, v13
    v_mul_f32 v15, v10, v13
    v_fma_f32 v9, -v14, v11, v9
    v_fma_f32 v10, -v15, v11, v10
    v_fmac_f32 v14, v9, v13
    v_fmac_f32 v15, v10, v13
    v_cvt_pk_bf16_f32 v19, v14, v15
    v_lshlrev_b32 v9, 16, v20
    v_and_b32 v10, s30, v20
    v_sub_f32 v9, v9, v8
    v_sub_f32 v10, v10, v8
    v_cvt_pk_bf16_f32 v12, v9, v10
    v_lshlrev_b32 v9, 16, v12
    v_and_b32 v10, s30, v12
    v_mul_f32 v14, v9, v13
    v_mul_f32 v15, v10, v13
    v_fma_f32 v9, -v14, v11, v9
    v_fma_f32 v10, -v15, v11, v10
    v_fmac_f32 v14, v9, v13
    v_fmac_f32 v15, v10, v13
    v_cvt_pk_bf16_f32 v20, v14, v15
    v_lshlrev_b32 v9, 16, v21
    v_and_b32 v10, s30, v21
    v_sub_f32 v9, v9, v8
    v_sub_f32 v10, v10, v8
    v_cvt_pk_bf16_f32 v12, v9, v10
    v_lshlrev_b32 v9, 16, v12
    v_and_b32 v10, s30, v12
    v_mul_f32 v14, v9, v13
    v_mul_f32 v15, v10, v13
    v_fma_f32 v9, -v14, v11, v9
    v_fma_f32 v10, -v15, v11, v10
    v_fmac_f32 v14, v9, v13
    v_fmac_f32 v15, v10, v13
    v_cvt_pk_bf16_f32 v21, v14, v15
    v_lshlrev_b32 v9, 16, v22
    v_and_b32 v10, s30, v22
    v_sub_f32 v9, v9, v8
    v_sub_f32 v10, v10, v8
    v_cvt_pk_bf16_f32 v12, v9, v10
    v_lshlrev_b32 v9, 16, v12
    v_and_b32 v10, s30, v12
    v_mul_f32 v14, v9, v13
    v_mul_f32 v15, v10, v13
    v_fma_f32 v9, -v14, v11, v9
    v_fma_f32 v10, -v15, v11, v10
    v_fmac_f32 v14, v9, v13
    v_fmac_f32 v15, v10, v13
    v_cvt_pk_bf16_f32 v22, v14, v15
    v_lshlrev_b32 v9, 16, v23
    v_and_b32 v10, s30, v23
    v_sub_f32 v9, v9, v8
    v_sub_f32 v10, v10, v8
    v_cvt_pk_bf16_f32 v12, v9, v10
    v_lshlrev_b32 v9, 16, v12
    v_and_b32 v10, s30, v12
    v_mul_f32 v14, v9, v13
    v_mul_f32 v15, v10, v13
    v_fma_f32 v9, -v14, v11, v9
    v_fma_f32 v10, -v15, v11, v10
    v_fmac_f32 v14, v9, v13
    v_fmac_f32 v15, v10, v13
    v_cvt_pk_bf16_f32 v23, v14, v15
    v_lshlrev_b32 v9, 16, v24
    v_and_b32 v10, s30, v24
    v_sub_f32 v9, v9, v8
    v_sub_f32 v10, v10, v8
    v_cvt_pk_bf16_f32 v12, v9, v10
    v_lshlrev_b32 v9, 16, v12
    v_and_b32 v10, s30, v12
    v_mul_f32 v14, v9, v13
    v_mul_f32 v15, v10, v13
    v_fma_f32 v9, -v14, v11, v9
    v_fma_f32 v10, -v15, v11, v10
    v_fmac_f32 v14, v9, v13
    v_fmac_f32 v15, v10, v13
    v_cvt_pk_bf16_f32 v24, v14, v15
    v_lshlrev_b32 v9, 16, v25
    v_and_b32 v10, s30, v25
    v_sub_f32 v9, v9, v8
    v_sub_f32 v10, v10, v8
    v_cvt_pk_bf16_f32 v12, v9, v10
    v_lshlrev_b32 v9, 16, v12
    v_and_b32 v10, s30, v12
    v_mul_f32 v14, v9, v13
    v_mul_f32 v15, v10, v13
    v_fma_f32 v9, -v14, v11, v9
    v_fma_f32 v10, -v15, v11, v10
    v_fmac_f32 v14, v9, v13
    v_fmac_f32 v15, v10, v13
    v_cvt_pk_bf16_f32 v25, v14, v15
    v_lshlrev_b32 v9, 16, v26
    v_and_b32 v10, s30, v26
    v_sub_f32 v9, v9, v8
    v_sub_f32 v10, v10, v8
    v_cvt_pk_bf16_f32 v12, v9, v10
    v_lshlrev_b32 v9, 16, v12
    v_and_b32 v10, s30, v12
    v_mul_f32 v14, v9, v13
    v_mul_f32 v15, v10, v13
    v_fma_f32 v9, -v14, v11, v9
    v_fma_f32 v10, -v15, v11, v10
    v_fmac_f32 v14, v9, v13
    v_fmac_f32 v15, v10, v13
    v_cvt_pk_bf16_f32 v26, v14, v15
    v_lshlrev_b32 v9, 16, v27
    v_and_b32 v10, s30, v27
    v_sub_f32 v9, v9, v8
    v_sub_f32 v10, v10, v8
    v_cvt_pk_bf16_f32 v12, v9, v10
    v_lshlrev_b32 v9, 16, v12
    v_and_b32 v10, s30, v12
    v_mul_f32 v14, v9, v13
    v_mul_f32 v15, v10, v13
    v_fma_f32 v9, -v14, v11, v9
    v_fma_f32 v10, -v15, v11, v10
    v_fmac_f32 v14, v9, v13
    v_fmac_f32 v15, v10, v13
    v_cvt_pk_bf16_f32 v27, v14, v15
    v_lshlrev_b32 v9, 16, v28
    v_and_b32 v10, s30, v28
    v_sub_f32 v9, v9, v8
    v_sub_f32 v10, v10, v8
    v_cvt_pk_bf16_f32 v12, v9, v10
    v_lshlrev_b32 v9, 16, v12
    v_and_b32 v10, s30, v12
    v_mul_f32 v14, v9, v13
    v_mul_f32 v15, v10, v13
    v_fma_f32 v9, -v14, v11, v9
    v_fma_f32 v10, -v15, v11, v10
    v_fmac_f32 v14, v9, v13
    v_fmac_f32 v15, v10, v13
    v_cvt_pk_bf16_f32 v28, v14, v15
    v_lshlrev_b32 v9, 16, v29
    v_and_b32 v10, s30, v29
    v_sub_f32 v9, v9, v8
    v_sub_f32 v10, v10, v8
    v_cvt_pk_bf16_f32 v12, v9, v10
    v_lshlrev_b32 v9, 16, v12
    v_and_b32 v10, s30, v12
    v_mul_f32 v14, v9, v13
    v_mul_f32 v15, v10, v13
    v_fma_f32 v9, -v14, v11, v9
    v_fma_f32 v10, -v15, v11, v10
    v_fmac_f32 v14, v9, v13
    v_fmac_f32 v15, v10, v13
    v_cvt_pk_bf16_f32 v29, v14, v15
    v_lshlrev_b32 v9, 16, v30
    v_and_b32 v10, s30, v30
    v_sub_f32 v9, v9, v8
    v_sub_f32 v10, v10, v8
    v_cvt_pk_bf16_f32 v12, v9, v10
    v_lshlrev_b32 v9, 16, v12
    v_and_b32 v10, s30, v12
    v_mul_f32 v14, v9, v13
    v_mul_f32 v15, v10, v13
    v_fma_f32 v9, -v14, v11, v9
    v_fma_f32 v10, -v15, v11, v10
    v_fmac_f32 v14, v9, v13
    v_fmac_f32 v15, v10, v13
    v_cvt_pk_bf16_f32 v30, v14, v15
    v_lshlrev_b32 v9, 16, v31
    v_and_b32 v10, s30, v31
    v_sub_f32 v9, v9, v8
    v_sub_f32 v10, v10, v8
    v_cvt_pk_bf16_f32 v12, v9, v10
    v_lshlrev_b32 v9, 16, v12
    v_and_b32 v10, s30, v12
    v_mul_f32 v14, v9, v13
    v_mul_f32 v15, v10, v13
    v_fma_f32 v9, -v14, v11, v9
    v_fma_f32 v10, -v15, v11, v10
    v_fmac_f32 v14, v9, v13
    v_fmac_f32 v15, v10, v13
    v_cvt_pk_bf16_f32 v31, v14, v15
    v_lshlrev_b32 v9, 16, v32
    v_and_b32 v10, s30, v32
    v_sub_f32 v9, v9, v8
    v_sub_f32 v10, v10, v8
    v_cvt_pk_bf16_f32 v12, v9, v10
    v_lshlrev_b32 v9, 16, v12
    v_and_b32 v10, s30, v12
    v_mul_f32 v14, v9, v13
    v_mul_f32 v15, v10, v13
    v_fma_f32 v9, -v14, v11, v9
    v_fma_f32 v10, -v15, v11, v10
    v_fmac_f32 v14, v9, v13
    v_fmac_f32 v15, v10, v13
    v_cvt_pk_bf16_f32 v32, v14, v15
    v_lshlrev_b32 v9, 16, v33
    v_and_b32 v10, s30, v33
    v_sub_f32 v9, v9, v8
    v_sub_f32 v10, v10, v8
    v_cvt_pk_bf16_f32 v12, v9, v10
    v_lshlrev_b32 v9, 16, v12
    v_and_b32 v10, s30, v12
    v_mul_f32 v14, v9, v13
    v_mul_f32 v15, v10, v13
    v_fma_f32 v9, -v14, v11, v9
    v_fma_f32 v10, -v15, v11, v10
    v_fmac_f32 v14, v9, v13
    v_fmac_f32 v15, v10, v13
    v_cvt_pk_bf16_f32 v33, v14, v15
    v_lshlrev_b32 v9, 16, v34
    v_and_b32 v10, s30, v34
    v_sub_f32 v9, v9, v8
    v_sub_f32 v10, v10, v8
    v_cvt_pk_bf16_f32 v12, v9, v10
    v_lshlrev_b32 v9, 16, v12
    v_and_b32 v10, s30, v12
    v_mul_f32 v14, v9, v13
    v_mul_f32 v15, v10, v13
    v_fma_f32 v9, -v14, v11, v9
    v_fma_f32 v10, -v15, v11, v10
    v_fmac_f32 v14, v9, v13
    v_fmac_f32 v15, v10, v13
    v_cvt_pk_bf16_f32 v34, v14, v15
    v_lshlrev_b32 v9, 16, v35
    v_and_b32 v10, s30, v35
    v_sub_f32 v9, v9, v8
    v_sub_f32 v10, v10, v8
    v_cvt_pk_bf16_f32 v12, v9, v10
    v_lshlrev_b32 v9, 16, v12
    v_and_b32 v10, s30, v12
    v_mul_f32 v14, v9, v13
    v_mul_f32 v15, v10, v13
    v_fma_f32 v9, -v14, v11, v9
    v_fma_f32 v10, -v15, v11, v10
    v_fmac_f32 v14, v9, v13
    v_fmac_f32 v15, v10, v13
    v_cvt_pk_bf16_f32 v35, v14, v15
    v_lshlrev_b32 v9, 16, v36
    v_and_b32 v10, s30, v36
    v_sub_f32 v9, v9, v8
    v_sub_f32 v10, v10, v8
    v_cvt_pk_bf16_f32 v12, v9, v10
    v_lshlrev_b32 v9, 16, v12
    v_and_b32 v10, s30, v12
    v_mul_f32 v14, v9, v13
    v_mul_f32 v15, v10, v13
    v_fma_f32 v9, -v14, v11, v9
    v_fma_f32 v10, -v15, v11, v10
    v_fmac_f32 v14, v9, v13
    v_fmac_f32 v15, v10, v13
    v_cvt_pk_bf16_f32 v36, v14, v15
    v_lshlrev_b32 v9, 16, v37
    v_and_b32 v10, s30, v37
    v_sub_f32 v9, v9, v8
    v_sub_f32 v10, v10, v8
    v_cvt_pk_bf16_f32 v12, v9, v10
    v_lshlrev_b32 v9, 16, v12
    v_and_b32 v10, s30, v12
    v_mul_f32 v14, v9, v13
    v_mul_f32 v15, v10, v13
    v_fma_f32 v9, -v14, v11, v9
    v_fma_f32 v10, -v15, v11, v10
    v_fmac_f32 v14, v9, v13
    v_fmac_f32 v15, v10, v13
    v_cvt_pk_bf16_f32 v37, v14, v15
    v_lshlrev_b32 v9, 16, v38
    v_and_b32 v10, s30, v38
    v_sub_f32 v9, v9, v8
    v_sub_f32 v10, v10, v8
    v_cvt_pk_bf16_f32 v12, v9, v10
    v_lshlrev_b32 v9, 16, v12
    v_and_b32 v10, s30, v12
    v_mul_f32 v14, v9, v13
    v_mul_f32 v15, v10, v13
    v_fma_f32 v9, -v14, v11, v9
    v_fma_f32 v10, -v15, v11, v10
    v_fmac_f32 v14, v9, v13
    v_fmac_f32 v15, v10, v13
    v_cvt_pk_bf16_f32 v38, v14, v15
    v_lshlrev_b32 v9, 16, v39
    v_and_b32 v10, s30, v39
    v_sub_f32 v9, v9, v8
    v_sub_f32 v10, v10, v8
    v_cvt_pk_bf16_f32 v12, v9, v10
    v_lshlrev_b32 v9, 16, v12
    v_and_b32 v10, s30, v12
    v_mul_f32 v14, v9, v13
    v_mul_f32 v15, v10, v13
    v_fma_f32 v9, -v14, v11, v9
    v_fma_f32 v10, -v15, v11, v10
    v_fmac_f32 v14, v9, v13
    v_fmac_f32 v15, v10, v13
    v_cvt_pk_bf16_f32 v39, v14, v15
    v_lshlrev_b32 v9, 16, v40
    v_and_b32 v10, s30, v40
    v_sub_f32 v9, v9, v8
    v_sub_f32 v10, v10, v8
    v_cvt_pk_bf16_f32 v12, v9, v10
    v_lshlrev_b32 v9, 16, v12
    v_and_b32 v10, s30, v12
    v_mul_f32 v14, v9, v13
    v_mul_f32 v15, v10, v13
    v_fma_f32 v9, -v14, v11, v9
    v_fma_f32 v10, -v15, v11, v10
    v_fmac_f32 v14, v9, v13
    v_fmac_f32 v15, v10, v13
    v_cvt_pk_bf16_f32 v40, v14, v15
    v_lshlrev_b32 v9, 16, v41
    v_and_b32 v10, s30, v41
    v_sub_f32 v9, v9, v8
    v_sub_f32 v10, v10, v8
    v_cvt_pk_bf16_f32 v12, v9, v10
    v_lshlrev_b32 v9, 16, v12
    v_and_b32 v10, s30, v12
    v_mul_f32 v14, v9, v13
    v_mul_f32 v15, v10, v13
    v_fma_f32 v9, -v14, v11, v9
    v_fma_f32 v10, -v15, v11, v10
    v_fmac_f32 v14, v9, v13
    v_fmac_f32 v15, v10, v13
    v_cvt_pk_bf16_f32 v41, v14, v15
    v_lshlrev_b32 v9, 16, v42
    v_and_b32 v10, s30, v42
    v_sub_f32 v9, v9, v8
    v_sub_f32 v10, v10, v8
    v_cvt_pk_bf16_f32 v12, v9, v10
    v_lshlrev_b32 v9, 16, v12
    v_and_b32 v10, s30, v12
    v_mul_f32 v14, v9, v13
    v_mul_f32 v15, v10, v13
    v_fma_f32 v9, -v14, v11, v9
    v_fma_f32 v10, -v15, v11, v10
    v_fmac_f32 v14, v9, v13
    v_fmac_f32 v15, v10, v13
    v_cvt_pk_bf16_f32 v42, v14, v15
    v_lshlrev_b32 v9, 16, v43
    v_and_b32 v10, s30, v43
    v_sub_f32 v9, v9, v8
    v_sub_f32 v10, v10, v8
    v_cvt_pk_bf16_f32 v12, v9, v10
    v_lshlrev_b32 v9, 16, v12
    v_and_b32 v10, s30, v12
    v_mul_f32 v14, v9, v13
    v_mul_f32 v15, v10, v13
    v_fma_f32 v9, -v14, v11, v9
    v_fma_f32 v10, -v15, v11, v10
    v_fmac_f32 v14, v9, v13
    v_fmac_f32 v15, v10, v13
    v_cvt_pk_bf16_f32 v43, v14, v15
    v_lshlrev_b32 v9, 16, v44
    v_and_b32 v10, s30, v44
    v_sub_f32 v9, v9, v8
    v_sub_f32 v10, v10, v8
    v_cvt_pk_bf16_f32 v12, v9, v10
    v_lshlrev_b32 v9, 16, v12
    v_and_b32 v10, s30, v12
    v_mul_f32 v14, v9, v13
    v_mul_f32 v15, v10, v13
    v_fma_f32 v9, -v14, v11, v9
    v_fma_f32 v10, -v15, v11, v10
    v_fmac_f32 v14, v9, v13
    v_fmac_f32 v15, v10, v13
    v_cvt_pk_bf16_f32 v44, v14, v15
    v_lshlrev_b32 v9, 16, v45
    v_and_b32 v10, s30, v45
    v_sub_f32 v9, v9, v8
    v_sub_f32 v10, v10, v8
    v_cvt_pk_bf16_f32 v12, v9, v10
    v_lshlrev_b32 v9, 16, v12
    v_and_b32 v10, s30, v12
    v_mul_f32 v14, v9, v13
    v_mul_f32 v15, v10, v13
    v_fma_f32 v9, -v14, v11, v9
    v_fma_f32 v10, -v15, v11, v10
    v_fmac_f32 v14, v9, v13
    v_fmac_f32 v15, v10, v13
    v_cvt_pk_bf16_f32 v45, v14, v15
    v_lshlrev_b32 v9, 16, v46
    v_and_b32 v10, s30, v46
    v_sub_f32 v9, v9, v8
    v_sub_f32 v10, v10, v8
    v_cvt_pk_bf16_f32 v12, v9, v10
    v_lshlrev_b32 v9, 16, v12
    v_and_b32 v10, s30, v12
    v_mul_f32 v14, v9, v13
    v_mul_f32 v15, v10, v13
    v_fma_f32 v9, -v14, v11, v9
    v_fma_f32 v10, -v15, v11, v10
    v_fmac_f32 v14, v9, v13
    v_fmac_f32 v15, v10, v13
    v_cvt_pk_bf16_f32 v46, v14, v15
    v_lshlrev_b32 v9, 16, v47
    v_and_b32 v10, s30, v47
    v_sub_f32 v9, v9, v8
    v_sub_f32 v10, v10, v8
    v_cvt_pk_bf16_f32 v12, v9, v10
    v_lshlrev_b32 v9, 16, v12
    v_and_b32 v10, s30, v12
    v_mul_f32 v14, v9, v13
    v_mul_f32 v15, v10, v13
    v_fma_f32 v9, -v14, v11, v9
    v_fma_f32 v10, -v15, v11, v10
    v_fmac_f32 v14, v9, v13
    v_fmac_f32 v15, v10, v13
    v_cvt_pk_bf16_f32 v47, v14, v15
    v_lshlrev_b32 v9, 16, v48
    v_and_b32 v10, s30, v48
    v_sub_f32 v9, v9, v8
    v_sub_f32 v10, v10, v8
    v_cvt_pk_bf16_f32 v12, v9, v10
    v_lshlrev_b32 v9, 16, v12
    v_and_b32 v10, s30, v12
    v_mul_f32 v14, v9, v13
    v_mul_f32 v15, v10, v13
    v_fma_f32 v9, -v14, v11, v9
    v_fma_f32 v10, -v15, v11, v10
    v_fmac_f32 v14, v9, v13
    v_fmac_f32 v15, v10, v13
    v_cvt_pk_bf16_f32 v48, v14, v15
    v_lshlrev_b32 v9, 16, v49
    v_and_b32 v10, s30, v49
    v_sub_f32 v9, v9, v8
    v_sub_f32 v10, v10, v8
    v_cvt_pk_bf16_f32 v12, v9, v10
    v_lshlrev_b32 v9, 16, v12
    v_and_b32 v10, s30, v12
    v_mul_f32 v14, v9, v13
    v_mul_f32 v15, v10, v13
    v_fma_f32 v9, -v14, v11, v9
    v_fma_f32 v10, -v15, v11, v10
    v_fmac_f32 v14, v9, v13
    v_fmac_f32 v15, v10, v13
    v_cvt_pk_bf16_f32 v49, v14, v15
    v_lshlrev_b32 v9, 16, v50
    v_and_b32 v10, s30, v50
    v_sub_f32 v9, v9, v8
    v_sub_f32 v10, v10, v8
    v_cvt_pk_bf16_f32 v12, v9, v10
    v_lshlrev_b32 v9, 16, v12
    v_and_b32 v10, s30, v12
    v_mul_f32 v14, v9, v13
    v_mul_f32 v15, v10, v13
    v_fma_f32 v9, -v14, v11, v9
    v_fma_f32 v10, -v15, v11, v10
    v_fmac_f32 v14, v9, v13
    v_fmac_f32 v15, v10, v13
    v_cvt_pk_bf16_f32 v50, v14, v15
    v_lshlrev_b32 v9, 16, v51
    v_and_b32 v10, s30, v51
    v_sub_f32 v9, v9, v8
    v_sub_f32 v10, v10, v8
    v_cvt_pk_bf16_f32 v12, v9, v10
    v_lshlrev_b32 v9, 16, v12
    v_and_b32 v10, s30, v12
    v_mul_f32 v14, v9, v13
    v_mul_f32 v15, v10, v13
    v_fma_f32 v9, -v14, v11, v9
    v_fma_f32 v10, -v15, v11, v10
    v_fmac_f32 v14, v9, v13
    v_fmac_f32 v15, v10, v13
    v_cvt_pk_bf16_f32 v51, v14, v15
    v_mul_u32_u24 v4, 1168, v2
    v_lshl_add_u32 v4, v3, 4, v4
    ds_write_b128 v4, v[16:19] offset:0
    ds_write_b128 v4, v[20:23] offset:128
    ds_write_b128 v4, v[24:27] offset:256
    ds_write_b128 v4, v[28:31] offset:384
    ds_write_b128 v4, v[32:35] offset:512
    ds_write_b128 v4, v[36:39] offset:640
    ds_write_b128 v4, v[40:43] offset:768
    ds_write_b128 v4, v[44:47] offset:896
    ds_write_b128 v4, v[48:51] offset:1024
    s_waitcnt lgkmcnt(0)
    s_barrier
    v_lshrrev_b32 v4, 6, v0
    v_lshrrev_b32 v5, 4, v1
    v_bfe_u32 v6, v1, 2, 2
    v_and_b32 v7, 3, v1
    v_lshl_add_u32 v8, v5, 3, v6
    v_mul_u32_u24 v8, 1168, v8
    v_lshl_add_u32 v8, v7, 3, v8
    v_mul_u32_u24 v9, 288, v4
    v_add_u32 v8, v8, v9
    v_mul_u32_u24 v10, 9, v4
    v_lshlrev_b32 v10, 16, v10
    v_lshl_add_u32 v10, v1, 4, v10
    s_lshl_b32 s21, s20, 10
    v_add_u32 v10, s21, v10
    ds_read_b64_tr_b16 v[12:13], v8 offset:0
    ds_read_b64_tr_b16 v[14:15], v8 offset:4672
    ds_read_b64_tr_b16 v[16:17], v8 offset:32
    ds_read_b64_tr_b16 v[18:19], v8 offset:4704
    ds_read_b64_tr_b16 v[20:21], v8 offset:64
    ds_read_b64_tr_b16 v[22:23], v8 offset:4736
    ds_read_b64_tr_b16 v[24:25], v8 offset:96
    ds_read_b64_tr_b16 v[26:27], v8 offset:4768
    ds_read_b64_tr_b16 v[28:29], v8 offset:128
    ds_read_b64_tr_b16 v[30:31], v8 offset:4800
    ds_read_b64_tr_b16 v[32:33], v8 offset:160
    ds_read_b64_tr_b16 v[34:35], v8 offset:4832
    ds_read_b64_tr_b16 v[36:37], v8 offset:192
    ds_read_b64_tr_b16 v[38:39], v8 offset:4864
    ds_read_b64_tr_b16 v[40:41], v8 offset:224
    ds_read_b64_tr_b16 v[42:43], v8 offset:4896
    ds_read_b64_tr_b16 v[44:45], v8 offset:256
    ds_read_b64_tr_b16 v[46:47], v8 offset:4928
    s_mov_b32 s22, 65536
    s_waitcnt lgkmcnt(15)
    buffer_store_dwordx4 v[12:15], v10, s[24:27], 0 offen
    v_add_u32 v10, s22, v10
    s_waitcnt lgkmcnt(14)
    buffer_store_dwordx4 v[16:19], v10, s[24:27], 0 offen
    v_add_u32 v10, s22, v10
    s_waitcnt lgkmcnt(12)
    buffer_store_dwordx4 v[20:23], v10, s[24:27], 0 offen
    v_add_u32 v10, s22, v10
    s_waitcnt lgkmcnt(10)
    buffer_store_dwordx4 v[24:27], v10, s[24:27], 0 offen
    v_add_u32 v10, s22, v10
    s_waitcnt lgkmcnt(8)
    buffer_store_dwordx4 v[28:31], v10, s[24:27], 0 offen
    v_add_u32 v10, s22, v10
    s_waitcnt lgkmcnt(6)
    buffer_store_dwordx4 v[32:35], v10, s[24:27], 0 offen
    v_add_u32 v10, s22, v10
    s_waitcnt lgkmcnt(4)
    buffer_store_dwordx4 v[36:39], v10, s[24:27], 0 offen
    v_add_u32 v10, s22, v10
    s_waitcnt lgkmcnt(2)
    buffer_store_dwordx4 v[40:43], v10, s[24:27], 0 offen
    v_add_u32 v10, s22, v10
    s_waitcnt lgkmcnt(0)
    buffer_store_dwordx4 v[44:47], v10, s[24:27], 0 offen
    s_endpgm
PREP_GATE:
    s_load_dwordx2 s[4:5], s[0:1], 0
    s_load_dwordx2 s[6:7], s[0:1], 120
    s_load_dwordx2 s[12:13], s[0:1], 96
    s_sub_u32 s20, s2, 64
    v_and_b32 v1, 63, v0
    v_lshrrev_b32 v2, 3, v0
    v_and_b32 v3, 7, v0
    s_lshl_b32 s21, s20, 5
    v_add_u32 v4, s21, v2
    v_mov_b32 v60, v4
    v_mul_u32_u24 v4, 1152, v4
    v_lshl_add_u32 v4, v3, 4, v4
    v_lshlrev_b32 v5, 4, v3
    s_waitcnt lgkmcnt(0)
    s_mov_b32 s8, s4
    s_and_b32 s9, s5, 0xffff
    s_mov_b32 s10, 2359296
    s_mov_b32 s11, 0x00020000
    s_add_u32 s24, s6, 2359296
    s_addc_u32 s25, s7, 0
    s_and_b32 s25, s25, 0xffff
    s_mov_b32 s26, 2359296
    s_mov_b32 s27, 0x00020000
    s_mov_b32 s16, s12
    s_and_b32 s17, s13, 0xffff
    s_mov_b32 s18, 1152
    s_mov_b32 s19, 0x00020000
    s_add_u32 s28, s6, 7077888
    s_addc_u32 s29, s7, 0
    s_and_b32 s29, s29, 0xffff
    s_mov_b32 s30, 8192
    s_mov_b32 s31, 0x00020000
    buffer_load_dwordx4 v[16:19], v4, s[8:11], 0 offen offset:0
    buffer_load_dwordx4 v[20:23], v4, s[8:11], 0 offen offset:128
    buffer_load_dwordx4 v[24:27], v4, s[8:11], 0 offen offset:256
    buffer_load_dwordx4 v[28:31], v4, s[8:11], 0 offen offset:384
    buffer_load_dwordx4 v[32:35], v4, s[8:11], 0 offen offset:512
    buffer_load_dwordx4 v[36:39], v4, s[8:11], 0 offen offset:640
    buffer_load_dwordx4 v[40:43], v4, s[8:11], 0 offen offset:768
    buffer_load_dwordx4 v[44:47], v4, s[8:11], 0 offen offset:896
    buffer_load_dwordx4 v[48:51], v4, s[8:11], 0 offen offset:1024
    buffer_load_dwordx4 v[64:67], v5, s[16:19], 0 offen offset:0
    buffer_load_dwordx4 v[68:71], v5, s[16:19], 0 offen offset:128
    buffer_load_dwordx4 v[72:75], v5, s[16:19], 0 offen offset:256
    buffer_load_dwordx4 v[76:79], v5, s[16:19], 0 offen offset:384
    buffer_load_dwordx4 v[80:83], v5, s[16:19], 0 offen offset:512
    buffer_load_dwordx4 v[84:87], v5, s[16:19], 0 offen offset:640
    buffer_load_dwordx4 v[88:91], v5, s[16:19], 0 offen offset:768
    buffer_load_dwordx4 v[92:95], v5, s[16:19], 0 offen offset:896
    buffer_load_dwordx4 v[96:99], v5, s[16:19], 0 offen offset:1024
    s_mov_b32 s30, 0xffff0000
    v_mov_b32 v8, 0
    s_waitcnt vmcnt(0)
    v_lshlrev_b32 v9, 16, v16
    v_and_b32 v10, s30, v16
    v_lshlrev_b32 v11, 16, v64
    v_and_b32 v12, s30, v64
    v_mul_f32 v9, v9, v11
    v_mul_f32 v10, v10, v12
    v_cvt_pk_bf16_f32 v12, v9, v10
    v_lshlrev_b32 v9, 16, v12
    v_and_b32 v10, s30, v12
    v_add_f32 v8, v8, v9
    v_add_f32 v8, v8, v10
    v_lshlrev_b32 v9, 16, v17
    v_and_b32 v10, s30, v17
    v_lshlrev_b32 v11, 16, v65
    v_and_b32 v12, s30, v65
    v_mul_f32 v9, v9, v11
    v_mul_f32 v10, v10, v12
    v_cvt_pk_bf16_f32 v12, v9, v10
    v_lshlrev_b32 v9, 16, v12
    v_and_b32 v10, s30, v12
    v_add_f32 v8, v8, v9
    v_add_f32 v8, v8, v10
    v_lshlrev_b32 v9, 16, v18
    v_and_b32 v10, s30, v18
    v_lshlrev_b32 v11, 16, v66
    v_and_b32 v12, s30, v66
    v_mul_f32 v9, v9, v11
    v_mul_f32 v10, v10, v12
    v_cvt_pk_bf16_f32 v12, v9, v10
    v_lshlrev_b32 v9, 16, v12
    v_and_b32 v10, s30, v12
    v_add_f32 v8, v8, v9
    v_add_f32 v8, v8, v10
    v_lshlrev_b32 v9, 16, v19
    v_and_b32 v10, s30, v19
    v_lshlrev_b32 v11, 16, v67
    v_and_b32 v12, s30, v67
    v_mul_f32 v9, v9, v11
    v_mul_f32 v10, v10, v12
    v_cvt_pk_bf16_f32 v12, v9, v10
    v_lshlrev_b32 v9, 16, v12
    v_and_b32 v10, s30, v12
    v_add_f32 v8, v8, v9
    v_add_f32 v8, v8, v10
    v_lshlrev_b32 v9, 16, v20
    v_and_b32 v10, s30, v20
    v_lshlrev_b32 v11, 16, v68
    v_and_b32 v12, s30, v68
    v_mul_f32 v9, v9, v11
    v_mul_f32 v10, v10, v12
    v_cvt_pk_bf16_f32 v12, v9, v10
    v_lshlrev_b32 v9, 16, v12
    v_and_b32 v10, s30, v12
    v_add_f32 v8, v8, v9
    v_add_f32 v8, v8, v10
    v_lshlrev_b32 v9, 16, v21
    v_and_b32 v10, s30, v21
    v_lshlrev_b32 v11, 16, v69
    v_and_b32 v12, s30, v69
    v_mul_f32 v9, v9, v11
    v_mul_f32 v10, v10, v12
    v_cvt_pk_bf16_f32 v12, v9, v10
    v_lshlrev_b32 v9, 16, v12
    v_and_b32 v10, s30, v12
    v_add_f32 v8, v8, v9
    v_add_f32 v8, v8, v10
    v_lshlrev_b32 v9, 16, v22
    v_and_b32 v10, s30, v22
    v_lshlrev_b32 v11, 16, v70
    v_and_b32 v12, s30, v70
    v_mul_f32 v9, v9, v11
    v_mul_f32 v10, v10, v12
    v_cvt_pk_bf16_f32 v12, v9, v10
    v_lshlrev_b32 v9, 16, v12
    v_and_b32 v10, s30, v12
    v_add_f32 v8, v8, v9
    v_add_f32 v8, v8, v10
    v_lshlrev_b32 v9, 16, v23
    v_and_b32 v10, s30, v23
    v_lshlrev_b32 v11, 16, v71
    v_and_b32 v12, s30, v71
    v_mul_f32 v9, v9, v11
    v_mul_f32 v10, v10, v12
    v_cvt_pk_bf16_f32 v12, v9, v10
    v_lshlrev_b32 v9, 16, v12
    v_and_b32 v10, s30, v12
    v_add_f32 v8, v8, v9
    v_add_f32 v8, v8, v10
    v_lshlrev_b32 v9, 16, v24
    v_and_b32 v10, s30, v24
    v_lshlrev_b32 v11, 16, v72
    v_and_b32 v12, s30, v72
    v_mul_f32 v9, v9, v11
    v_mul_f32 v10, v10, v12
    v_cvt_pk_bf16_f32 v12, v9, v10
    v_lshlrev_b32 v9, 16, v12
    v_and_b32 v10, s30, v12
    v_add_f32 v8, v8, v9
    v_add_f32 v8, v8, v10
    v_lshlrev_b32 v9, 16, v25
    v_and_b32 v10, s30, v25
    v_lshlrev_b32 v11, 16, v73
    v_and_b32 v12, s30, v73
    v_mul_f32 v9, v9, v11
    v_mul_f32 v10, v10, v12
    v_cvt_pk_bf16_f32 v12, v9, v10
    v_lshlrev_b32 v9, 16, v12
    v_and_b32 v10, s30, v12
    v_add_f32 v8, v8, v9
    v_add_f32 v8, v8, v10
    v_lshlrev_b32 v9, 16, v26
    v_and_b32 v10, s30, v26
    v_lshlrev_b32 v11, 16, v74
    v_and_b32 v12, s30, v74
    v_mul_f32 v9, v9, v11
    v_mul_f32 v10, v10, v12
    v_cvt_pk_bf16_f32 v12, v9, v10
    v_lshlrev_b32 v9, 16, v12
    v_and_b32 v10, s30, v12
    v_add_f32 v8, v8, v9
    v_add_f32 v8, v8, v10
    v_lshlrev_b32 v9, 16, v27
    v_and_b32 v10, s30, v27
    v_lshlrev_b32 v11, 16, v75
    v_and_b32 v12, s30, v75
    v_mul_f32 v9, v9, v11
    v_mul_f32 v10, v10, v12
    v_cvt_pk_bf16_f32 v12, v9, v10
    v_lshlrev_b32 v9, 16, v12
    v_and_b32 v10, s30, v12
    v_add_f32 v8, v8, v9
    v_add_f32 v8, v8, v10
    v_lshlrev_b32 v9, 16, v28
    v_and_b32 v10, s30, v28
    v_lshlrev_b32 v11, 16, v76
    v_and_b32 v12, s30, v76
    v_mul_f32 v9, v9, v11
    v_mul_f32 v10, v10, v12
    v_cvt_pk_bf16_f32 v12, v9, v10
    v_lshlrev_b32 v9, 16, v12
    v_and_b32 v10, s30, v12
    v_add_f32 v8, v8, v9
    v_add_f32 v8, v8, v10
    v_lshlrev_b32 v9, 16, v29
    v_and_b32 v10, s30, v29
    v_lshlrev_b32 v11, 16, v77
    v_and_b32 v12, s30, v77
    v_mul_f32 v9, v9, v11
    v_mul_f32 v10, v10, v12
    v_cvt_pk_bf16_f32 v12, v9, v10
    v_lshlrev_b32 v9, 16, v12
    v_and_b32 v10, s30, v12
    v_add_f32 v8, v8, v9
    v_add_f32 v8, v8, v10
    v_lshlrev_b32 v9, 16, v30
    v_and_b32 v10, s30, v30
    v_lshlrev_b32 v11, 16, v78
    v_and_b32 v12, s30, v78
    v_mul_f32 v9, v9, v11
    v_mul_f32 v10, v10, v12
    v_cvt_pk_bf16_f32 v12, v9, v10
    v_lshlrev_b32 v9, 16, v12
    v_and_b32 v10, s30, v12
    v_add_f32 v8, v8, v9
    v_add_f32 v8, v8, v10
    v_lshlrev_b32 v9, 16, v31
    v_and_b32 v10, s30, v31
    v_lshlrev_b32 v11, 16, v79
    v_and_b32 v12, s30, v79
    v_mul_f32 v9, v9, v11
    v_mul_f32 v10, v10, v12
    v_cvt_pk_bf16_f32 v12, v9, v10
    v_lshlrev_b32 v9, 16, v12
    v_and_b32 v10, s30, v12
    v_add_f32 v8, v8, v9
    v_add_f32 v8, v8, v10
    v_lshlrev_b32 v9, 16, v32
    v_and_b32 v10, s30, v32
    v_lshlrev_b32 v11, 16, v80
    v_and_b32 v12, s30, v80
    v_mul_f32 v9, v9, v11
    v_mul_f32 v10, v10, v12
    v_cvt_pk_bf16_f32 v12, v9, v10
    v_lshlrev_b32 v9, 16, v12
    v_and_b32 v10, s30, v12
    v_add_f32 v8, v8, v9
    v_add_f32 v8, v8, v10
    v_lshlrev_b32 v9, 16, v33
    v_and_b32 v10, s30, v33
    v_lshlrev_b32 v11, 16, v81
    v_and_b32 v12, s30, v81
    v_mul_f32 v9, v9, v11
    v_mul_f32 v10, v10, v12
    v_cvt_pk_bf16_f32 v12, v9, v10
    v_lshlrev_b32 v9, 16, v12
    v_and_b32 v10, s30, v12
    v_add_f32 v8, v8, v9
    v_add_f32 v8, v8, v10
    v_lshlrev_b32 v9, 16, v34
    v_and_b32 v10, s30, v34
    v_lshlrev_b32 v11, 16, v82
    v_and_b32 v12, s30, v82
    v_mul_f32 v9, v9, v11
    v_mul_f32 v10, v10, v12
    v_cvt_pk_bf16_f32 v12, v9, v10
    v_lshlrev_b32 v9, 16, v12
    v_and_b32 v10, s30, v12
    v_add_f32 v8, v8, v9
    v_add_f32 v8, v8, v10
    v_lshlrev_b32 v9, 16, v35
    v_and_b32 v10, s30, v35
    v_lshlrev_b32 v11, 16, v83
    v_and_b32 v12, s30, v83
    v_mul_f32 v9, v9, v11
    v_mul_f32 v10, v10, v12
    v_cvt_pk_bf16_f32 v12, v9, v10
    v_lshlrev_b32 v9, 16, v12
    v_and_b32 v10, s30, v12
    v_add_f32 v8, v8, v9
    v_add_f32 v8, v8, v10
    v_lshlrev_b32 v9, 16, v36
    v_and_b32 v10, s30, v36
    v_lshlrev_b32 v11, 16, v84
    v_and_b32 v12, s30, v84
    v_mul_f32 v9, v9, v11
    v_mul_f32 v10, v10, v12
    v_cvt_pk_bf16_f32 v12, v9, v10
    v_lshlrev_b32 v9, 16, v12
    v_and_b32 v10, s30, v12
    v_add_f32 v8, v8, v9
    v_add_f32 v8, v8, v10
    v_lshlrev_b32 v9, 16, v37
    v_and_b32 v10, s30, v37
    v_lshlrev_b32 v11, 16, v85
    v_and_b32 v12, s30, v85
    v_mul_f32 v9, v9, v11
    v_mul_f32 v10, v10, v12
    v_cvt_pk_bf16_f32 v12, v9, v10
    v_lshlrev_b32 v9, 16, v12
    v_and_b32 v10, s30, v12
    v_add_f32 v8, v8, v9
    v_add_f32 v8, v8, v10
    v_lshlrev_b32 v9, 16, v38
    v_and_b32 v10, s30, v38
    v_lshlrev_b32 v11, 16, v86
    v_and_b32 v12, s30, v86
    v_mul_f32 v9, v9, v11
    v_mul_f32 v10, v10, v12
    v_cvt_pk_bf16_f32 v12, v9, v10
    v_lshlrev_b32 v9, 16, v12
    v_and_b32 v10, s30, v12
    v_add_f32 v8, v8, v9
    v_add_f32 v8, v8, v10
    v_lshlrev_b32 v9, 16, v39
    v_and_b32 v10, s30, v39
    v_lshlrev_b32 v11, 16, v87
    v_and_b32 v12, s30, v87
    v_mul_f32 v9, v9, v11
    v_mul_f32 v10, v10, v12
    v_cvt_pk_bf16_f32 v12, v9, v10
    v_lshlrev_b32 v9, 16, v12
    v_and_b32 v10, s30, v12
    v_add_f32 v8, v8, v9
    v_add_f32 v8, v8, v10
    v_lshlrev_b32 v9, 16, v40
    v_and_b32 v10, s30, v40
    v_lshlrev_b32 v11, 16, v88
    v_and_b32 v12, s30, v88
    v_mul_f32 v9, v9, v11
    v_mul_f32 v10, v10, v12
    v_cvt_pk_bf16_f32 v12, v9, v10
    v_lshlrev_b32 v9, 16, v12
    v_and_b32 v10, s30, v12
    v_add_f32 v8, v8, v9
    v_add_f32 v8, v8, v10
    v_lshlrev_b32 v9, 16, v41
    v_and_b32 v10, s30, v41
    v_lshlrev_b32 v11, 16, v89
    v_and_b32 v12, s30, v89
    v_mul_f32 v9, v9, v11
    v_mul_f32 v10, v10, v12
    v_cvt_pk_bf16_f32 v12, v9, v10
    v_lshlrev_b32 v9, 16, v12
    v_and_b32 v10, s30, v12
    v_add_f32 v8, v8, v9
    v_add_f32 v8, v8, v10
    v_lshlrev_b32 v9, 16, v42
    v_and_b32 v10, s30, v42
    v_lshlrev_b32 v11, 16, v90
    v_and_b32 v12, s30, v90
    v_mul_f32 v9, v9, v11
    v_mul_f32 v10, v10, v12
    v_cvt_pk_bf16_f32 v12, v9, v10
    v_lshlrev_b32 v9, 16, v12
    v_and_b32 v10, s30, v12
    v_add_f32 v8, v8, v9
    v_add_f32 v8, v8, v10
    v_lshlrev_b32 v9, 16, v43
    v_and_b32 v10, s30, v43
    v_lshlrev_b32 v11, 16, v91
    v_and_b32 v12, s30, v91
    v_mul_f32 v9, v9, v11
    v_mul_f32 v10, v10, v12
    v_cvt_pk_bf16_f32 v12, v9, v10
    v_lshlrev_b32 v9, 16, v12
    v_and_b32 v10, s30, v12
    v_add_f32 v8, v8, v9
    v_add_f32 v8, v8, v10
    v_lshlrev_b32 v9, 16, v44
    v_and_b32 v10, s30, v44
    v_lshlrev_b32 v11, 16, v92
    v_and_b32 v12, s30, v92
    v_mul_f32 v9, v9, v11
    v_mul_f32 v10, v10, v12
    v_cvt_pk_bf16_f32 v12, v9, v10
    v_lshlrev_b32 v9, 16, v12
    v_and_b32 v10, s30, v12
    v_add_f32 v8, v8, v9
    v_add_f32 v8, v8, v10
    v_lshlrev_b32 v9, 16, v45
    v_and_b32 v10, s30, v45
    v_lshlrev_b32 v11, 16, v93
    v_and_b32 v12, s30, v93
    v_mul_f32 v9, v9, v11
    v_mul_f32 v10, v10, v12
    v_cvt_pk_bf16_f32 v12, v9, v10
    v_lshlrev_b32 v9, 16, v12
    v_and_b32 v10, s30, v12
    v_add_f32 v8, v8, v9
    v_add_f32 v8, v8, v10
    v_lshlrev_b32 v9, 16, v46
    v_and_b32 v10, s30, v46
    v_lshlrev_b32 v11, 16, v94
    v_and_b32 v12, s30, v94
    v_mul_f32 v9, v9, v11
    v_mul_f32 v10, v10, v12
    v_cvt_pk_bf16_f32 v12, v9, v10
    v_lshlrev_b32 v9, 16, v12
    v_and_b32 v10, s30, v12
    v_add_f32 v8, v8, v9
    v_add_f32 v8, v8, v10
    v_lshlrev_b32 v9, 16, v47
    v_and_b32 v10, s30, v47
    v_lshlrev_b32 v11, 16, v95
    v_and_b32 v12, s30, v95
    v_mul_f32 v9, v9, v11
    v_mul_f32 v10, v10, v12
    v_cvt_pk_bf16_f32 v12, v9, v10
    v_lshlrev_b32 v9, 16, v12
    v_and_b32 v10, s30, v12
    v_add_f32 v8, v8, v9
    v_add_f32 v8, v8, v10
    v_lshlrev_b32 v9, 16, v48
    v_and_b32 v10, s30, v48
    v_lshlrev_b32 v11, 16, v96
    v_and_b32 v12, s30, v96
    v_mul_f32 v9, v9, v11
    v_mul_f32 v10, v10, v12
    v_cvt_pk_bf16_f32 v12, v9, v10
    v_lshlrev_b32 v9, 16, v12
    v_and_b32 v10, s30, v12
    v_add_f32 v8, v8, v9
    v_add_f32 v8, v8, v10
    v_lshlrev_b32 v9, 16, v49
    v_and_b32 v10, s30, v49
    v_lshlrev_b32 v11, 16, v97
    v_and_b32 v12, s30, v97
    v_mul_f32 v9, v9, v11
    v_mul_f32 v10, v10, v12
    v_cvt_pk_bf16_f32 v12, v9, v10
    v_lshlrev_b32 v9, 16, v12
    v_and_b32 v10, s30, v12
    v_add_f32 v8, v8, v9
    v_add_f32 v8, v8, v10
    v_lshlrev_b32 v9, 16, v50
    v_and_b32 v10, s30, v50
    v_lshlrev_b32 v11, 16, v98
    v_and_b32 v12, s30, v98
    v_mul_f32 v9, v9, v11
    v_mul_f32 v10, v10, v12
    v_cvt_pk_bf16_f32 v12, v9, v10
    v_lshlrev_b32 v9, 16, v12
    v_and_b32 v10, s30, v12
    v_add_f32 v8, v8, v9
    v_add_f32 v8, v8, v10
    v_lshlrev_b32 v9, 16, v51
    v_and_b32 v10, s30, v51
    v_lshlrev_b32 v11, 16, v99
    v_and_b32 v12, s30, v99
    v_mul_f32 v9, v9, v11
    v_mul_f32 v10, v10, v12
    v_cvt_pk_bf16_f32 v12, v9, v10
    v_lshlrev_b32 v9, 16, v12
    v_and_b32 v10, s30, v12
    v_add_f32 v8, v8, v9
    v_add_f32 v8, v8, v10
    s_nop 1
    v_add_f32_dpp v8, v8, v8 quad_perm:[1,0,3,2] row_mask:0xf bank_mask:0xf
    s_nop 1
    v_add_f32_dpp v8, v8, v8 quad_perm:[2,3,0,1] row_mask:0xf bank_mask:0xf
    s_nop 1
    v_add_f32_dpp v8, v8, v8 row_half_mirror row_mask:0xf bank_mask:0xf
    v_cvt_pk_bf16_f32 v12, v8, v8
    v_lshlrev_b32 v8, 16, v12
    v_mul_f32 v8, 0x3fb8aa3b, v8
    v_sub_f32 v8, 0, v8
    v_exp_f32 v8, v8
    s_nop 0
    v_add_f32 v8, 1.0, v8
    v_rcp_f32 v8, v8
    s_nop 0
    v_cvt_pk_bf16_f32 v12, v8, v8
    v_lshlrev_b32 v8, 16, v12
    v_lshlrev_b32 v9, 2, v60
    v_cmp_eq_u32 vcc, 0, v3
    s_and_saveexec_b64 s[32:33], vcc
    buffer_store_dword v8, v9, s[28:31], 0 offen
    s_mov_b64 exec, s[32:33]
    v_mul_u32_u24 v4, 1168, v2
    v_lshl_add_u32 v4, v3, 4, v4
    ds_write_b128 v4, v[16:19] offset:0
    ds_write_b128 v4, v[20:23] offset:128
    ds_write_b128 v4, v[24:27] offset:256
    ds_write_b128 v4, v[28:31] offset:384
    ds_write_b128 v4, v[32:35] offset:512
    ds_write_b128 v4, v[36:39] offset:640
    ds_write_b128 v4, v[40:43] offset:768
    ds_write_b128 v4, v[44:47] offset:896
    ds_write_b128 v4, v[48:51] offset:1024
    s_waitcnt lgkmcnt(0)
    s_barrier
    v_lshrrev_b32 v4, 6, v0
    v_lshrrev_b32 v5, 4, v1
    v_bfe_u32 v6, v1, 2, 2
    v_and_b32 v7, 3, v1
    v_lshl_add_u32 v8, v5, 3, v6
    v_mul_u32_u24 v8, 1168, v8
    v_lshl_add_u32 v8, v7, 3, v8
    v_mul_u32_u24 v9, 288, v4
    v_add_u32 v8, v8, v9
    v_mul_u32_u24 v10, 144, v4
    v_and_b32 v11, 15, v1
    v_add_u32 v10, v10, v11
    v_lshlrev_b32 v10, 12, v10
    v_lshl_add_u32 v10, v5, 4, v10
    s_lshl_b32 s21, s20, 6
    v_add_u32 v10, s21, v10
    ds_read_b64_tr_b16 v[12:13], v8 offset:0
    ds_read_b64_tr_b16 v[14:15], v8 offset:4672
    ds_read_b64_tr_b16 v[16:17], v8 offset:32
    ds_read_b64_tr_b16 v[18:19], v8 offset:4704
    ds_read_b64_tr_b16 v[20:21], v8 offset:64
    ds_read_b64_tr_b16 v[22:23], v8 offset:4736
    ds_read_b64_tr_b16 v[24:25], v8 offset:96
    ds_read_b64_tr_b16 v[26:27], v8 offset:4768
    ds_read_b64_tr_b16 v[28:29], v8 offset:128
    ds_read_b64_tr_b16 v[30:31], v8 offset:4800
    ds_read_b64_tr_b16 v[32:33], v8 offset:160
    ds_read_b64_tr_b16 v[34:35], v8 offset:4832
    ds_read_b64_tr_b16 v[36:37], v8 offset:192
    ds_read_b64_tr_b16 v[38:39], v8 offset:4864
    ds_read_b64_tr_b16 v[40:41], v8 offset:224
    ds_read_b64_tr_b16 v[42:43], v8 offset:4896
    ds_read_b64_tr_b16 v[44:45], v8 offset:256
    ds_read_b64_tr_b16 v[46:47], v8 offset:4928
    s_mov_b32 s22, 65536
    s_waitcnt lgkmcnt(15)
    buffer_store_dwordx4 v[12:15], v10, s[24:27], 0 offen
    v_add_u32 v10, s22, v10
    s_waitcnt lgkmcnt(14)
    buffer_store_dwordx4 v[16:19], v10, s[24:27], 0 offen
    v_add_u32 v10, s22, v10
    s_waitcnt lgkmcnt(12)
    buffer_store_dwordx4 v[20:23], v10, s[24:27], 0 offen
    v_add_u32 v10, s22, v10
    s_waitcnt lgkmcnt(10)
    buffer_store_dwordx4 v[24:27], v10, s[24:27], 0 offen
    v_add_u32 v10, s22, v10
    s_waitcnt lgkmcnt(8)
    buffer_store_dwordx4 v[28:31], v10, s[24:27], 0 offen
    v_add_u32 v10, s22, v10
    s_waitcnt lgkmcnt(6)
    buffer_store_dwordx4 v[32:35], v10, s[24:27], 0 offen
    v_add_u32 v10, s22, v10
    s_waitcnt lgkmcnt(4)
    buffer_store_dwordx4 v[36:39], v10, s[24:27], 0 offen
    v_add_u32 v10, s22, v10
    s_waitcnt lgkmcnt(2)
    buffer_store_dwordx4 v[40:43], v10, s[24:27], 0 offen
    v_add_u32 v10, s22, v10
    s_waitcnt lgkmcnt(0)
    buffer_store_dwordx4 v[44:47], v10, s[24:27], 0 offen
    s_endpgm
.globl gemm1_kernel
.p2align 8
.type gemm1_kernel,@function
gemm1_kernel:
    s_cmp_lt_u32 s2, 216
    s_cbranch_scc1 G1_START
    s_cmp_lt_u32 s2, 792
    s_cbranch_scc1 CONV_START
G1_END:
    s_endpgm
G1_START:
    s_load_dwordx2 s[4:5], s[0:1], 64
    s_load_dwordx2 s[6:7], s[0:1], 120
    s_load_dwordx2 s[8:9], s[0:1], 72
    s_and_b32 s28, s2, 7
    s_mul_i32 s28, s28, 27
    s_lshr_b32 s29, s2, 3
    s_add_u32 s28, s28, s29
    s_mul_i32 s29, s28, 43691
    s_lshr_b32 s29, s29, 18
    s_mul_i32 s30, s29, 6
    s_sub_u32 s28, s28, s30
    v_and_b32 v1, 63, v0
    v_lshrrev_b32 v2, 6, v0
    s_nop 0
    v_readfirstlane_b32 s31, v2
    s_and_b32 s30, s31, 3
    v_lshrrev_b32 v3, 4, v1
    v_bfe_u32 v4, v1, 2, 2
    v_and_b32 v5, 3, v1
    s_waitcnt lgkmcnt(0)
    s_mov_b32 s12, s4
    s_and_b32 s13, s5, 0xffff
    s_mov_b32 s14, 18874368
    s_mov_b32 s15, 0x00020000
    s_add_u32 s16, s6, 0
    s_addc_u32 s17, s7, 0
    s_and_b32 s17, s17, 0xffff
    s_mov_b32 s18, 2359296
    s_mov_b32 s19, 0x00020000
    s_add_u32 s20, s6, 12451840
    s_addc_u32 s21, s7, 0
    s_and_b32 s21, s21, 0xffff
    s_mov_b32 s22, 5308416
    s_mov_b32 s23, 0x00020000
    s_mov_b32 s24, s8
    s_and_b32 s25, s9, 0xffff
    s_mov_b32 s26, 9216
    s_mov_b32 s27, 0x00020000
    s_lshr_b32 s46, s30, 1
    s_and_b32 s47, s30, 1
    v_mov_b32 v6, s47
    v_lshl_or_b32 v6, v6, 2, v3
    v_lshlrev_b32 v6, 1, v6
    v_and_b32 v7, 15, v1
    v_xor_b32 v6, v6, v7
    v_lshlrev_b32 v6, 4, v6
    v_mul_u32_u24 v15, 9216, v3
    v_add_u32 v15, v15, v6
    v_lshlrev_b32 v16, 4, v1
    v_and_b32 v6, 1, v3
    v_lshl_or_b32 v6, v6, 2, v4
    v_lshlrev_b32 v6, 1, v6
    v_lshl_add_u32 v7, v3, 3, v4
    v_lshlrev_b32 v7, 8, v7
    v_and_b32 v8, 1, v5
    v_lshl_add_u32 v7, v8, 3, v7
    v_lshrrev_b32 v8, 1, v5
    s_lshl_b32 s44, s46, 3
    v_add_u32 v8, s44, v8
    v_add_u32 v9, 0, v8
    v_xor_b32 v9, v9, v6
    v_lshl_add_u32 v10, v9, 4, v7
    v_add_u32 v9, 2, v8
    v_xor_b32 v9, v9, v6
    v_lshl_add_u32 v11, v9, 4, v7
    v_add_u32 v9, 4, v8
    v_xor_b32 v9, v9, v6
    v_lshl_add_u32 v12, v9, 4, v7
    v_add_u32 v9, 6, v8
    v_xor_b32 v9, v9, v6
    v_lshl_add_u32 v13, v9, 4, v7
    s_mul_i32 s44, s47, 3072
    s_add_u32 s44, s44, 8192
    v_add_u32 v14, s44, v16
    s_mov_b32 s33, 0
    s_mov_b32 s34, 0
    s_mul_i32 s35, s30, 73728
    s_lshl_b32 s44, s29, 8
    s_add_u32 s35, s35, s44
    s_lshl_b32 s44, s30, 1
    s_add_u32 s45, s30, 2
    s_cmp_lt_u32 s30, 2
    s_cselect_b32 s40, s44, s45
    s_cselect_b32 s42, 1, 0
    s_add_u32 s44, s30, 4
    s_lshl_b32 s45, s30, 1
    s_sub_u32 s45, s45, 4
    s_cmp_lt_u32 s30, 2
    s_cselect_b32 s41, s44, s45
    s_mul_i32 s43, s28, 6
    s_add_u32 s36, s43, s40
    s_lshl_b32 s36, s36, 16
    s_add_u32 s37, s43, s41
    s_lshl_b32 s37, s37, 16
    s_lshl_b32 s40, s40, 10
    s_add_u32 s40, s40, 8192
    s_lshl_b32 s41, s41, 10
    s_add_u32 s41, s41, 8192
    s_lshl_b32 s39, s30, 11
    s_mov_b32 s38, 0
    v_mov_b32 v80, 0
    v_mov_b32 v81, 0
    v_mov_b32 v82, 0
    v_mov_b32 v83, 0
    v_mov_b32 v84, 0
    v_mov_b32 v85, 0
    v_mov_b32 v86, 0
    v_mov_b32 v87, 0
    v_mov_b32 v88, 0
    v_mov_b32 v89, 0
    v_mov_b32 v90, 0
    v_mov_b32 v91, 0
    v_mov_b32 v92, 0
    v_mov_b32 v93, 0
    v_mov_b32 v94, 0
    v_mov_b32 v95, 0
    v_mov_b32 v96, 0
    v_mov_b32 v97, 0
    v_mov_b32 v98, 0
    v_mov_b32 v99, 0
    v_mov_b32 v100, 0
    v_mov_b32 v101, 0
    v_mov_b32 v102, 0
    v_mov_b32 v103, 0
    v_mov_b32 v104, 0
    v_mov_b32 v105, 0
    v_mov_b32 v106, 0
    v_mov_b32 v107, 0
    v_mov_b32 v108, 0
    v_mov_b32 v109, 0
    v_mov_b32 v110, 0
    v_mov_b32 v111, 0
    v_mov_b32 v112, 0
    v_mov_b32 v113, 0
    v_mov_b32 v114, 0
    v_mov_b32 v115, 0
    v_mov_b32 v116, 0
    v_mov_b32 v117, 0
    v_mov_b32 v118, 0
    v_mov_b32 v119, 0
    v_mov_b32 v120, 0
    v_mov_b32 v121, 0
    v_mov_b32 v122, 0
    v_mov_b32 v123, 0
    v_mov_b32 v124, 0
    v_mov_b32 v125, 0
    v_mov_b32 v126, 0
    v_mov_b32 v127, 0
    s_cmp_ge_u32 s31, 4
    s_cbranch_scc1 G1_PROD
    s_barrier
    v_add_u32 v17, s34, v10
    v_add_u32 v18, s34, v11
    v_add_u32 v19, s34, v12
    v_add_u32 v20, s34, v13
    v_add_u32 v21, s34, v14
    ds_read_b64_tr_b16 v[24:25], v17
    ds_read_b64_tr_b16 v[26:27], v17 offset:1024
    ds_read_b64_tr_b16 v[28:29], v18
    ds_read_b64_tr_b16 v[30:31], v18 offset:1024
    ds_read_b64_tr_b16 v[32:33], v19
    ds_read_b64_tr_b16 v[34:35], v19 offset:1024
    ds_read_b64_tr_b16 v[36:37], v20
    ds_read_b64_tr_b16 v[38:39], v20 offset:1024
    ds_read_b128 v[40:43], v21 offset:0
    ds_read_b128 v[44:47], v21 offset:1024
    ds_read_b128 v[48:51], v21 offset:2048
    s_add_u32 s34, s34, 14336
    s_cmp_eq_u32 s34, 71680
    s_cselect_b32 s34, 0, s34
    s_mov_b32 s48, 0
G1_LOOP:
    s_waitcnt lgkmcnt(0)
    s_barrier
    v_mfma_f32_16x16x32_bf16 v[80:83], v[24:27], v[40:43], v[80:83]
    v_add_u32 v17, s34, v10
    v_add_u32 v18, s34, v11
    v_add_u32 v19, s34, v12
    v_add_u32 v20, s34, v13
    v_add_u32 v21, s34, v14
    ds_read_b64_tr_b16 v[52:53], v17
    ds_read_b64_tr_b16 v[54:55], v17 offset:1024
    v_mfma_f32_16x16x32_bf16 v[84:87], v[24:27], v[44:47], v[84:87]
    ds_read_b64_tr_b16 v[56:57], v18
    ds_read_b64_tr_b16 v[58:59], v18 offset:1024
    ds_read_b64_tr_b16 v[60:61], v19
    ds_read_b64_tr_b16 v[62:63], v19 offset:1024
    v_mfma_f32_16x16x32_bf16 v[88:91], v[24:27], v[48:51], v[88:91]
    ds_read_b64_tr_b16 v[64:65], v20
    ds_read_b64_tr_b16 v[66:67], v20 offset:1024
    ds_read_b128 v[68:71], v21 offset:0
    v_mfma_f32_16x16x32_bf16 v[92:95], v[28:31], v[40:43], v[92:95]
    ds_read_b128 v[72:75], v21 offset:1024
    ds_read_b128 v[76:79], v21 offset:2048
    v_mfma_f32_16x16x32_bf16 v[96:99], v[28:31], v[44:47], v[96:99]
    s_add_u32 s34, s34, 14336
    s_cmp_eq_u32 s34, 71680
    s_cselect_b32 s34, 0, s34
    v_mfma_f32_16x16x32_bf16 v[100:103], v[28:31], v[48:51], v[100:103]
    v_mfma_f32_16x16x32_bf16 v[104:107], v[32:35], v[40:43], v[104:107]
    v_mfma_f32_16x16x32_bf16 v[108:111], v[32:35], v[44:47], v[108:111]
    v_mfma_f32_16x16x32_bf16 v[112:115], v[32:35], v[48:51], v[112:115]
    v_mfma_f32_16x16x32_bf16 v[116:119], v[36:39], v[40:43], v[116:119]
    v_mfma_f32_16x16x32_bf16 v[120:123], v[36:39], v[44:47], v[120:123]
    v_mfma_f32_16x16x32_bf16 v[124:127], v[36:39], v[48:51], v[124:127]
    s_waitcnt lgkmcnt(0)
    s_barrier
    v_mfma_f32_16x16x32_bf16 v[80:83], v[52:55], v[68:71], v[80:83]
    v_add_u32 v17, s34, v10
    v_add_u32 v18, s34, v11
    v_add_u32 v19, s34, v12
    v_add_u32 v20, s34, v13
    v_add_u32 v21, s34, v14
    ds_read_b64_tr_b16 v[24:25], v17
    ds_read_b64_tr_b16 v[26:27], v17 offset:1024
    v_mfma_f32_16x16x32_bf16 v[84:87], v[52:55], v[72:75], v[84:87]
    ds_read_b64_tr_b16 v[28:29], v18
    ds_read_b64_tr_b16 v[30:31], v18 offset:1024
    ds_read_b64_tr_b16 v[32:33], v19
    ds_read_b64_tr_b16 v[34:35], v19 offset:1024
    v_mfma_f32_16x16x32_bf16 v[88:91], v[52:55], v[76:79], v[88:91]
    ds_read_b64_tr_b16 v[36:37], v20
    ds_read_b64_tr_b16 v[38:39], v20 offset:1024
    ds_read_b128 v[40:43], v21 offset:0
    v_mfma_f32_16x16x32_bf16 v[92:95], v[56:59], v[68:71], v[92:95]
    ds_read_b128 v[44:47], v21 offset:1024
    ds_read_b128 v[48:51], v21 offset:2048
    v_mfma_f32_16x16x32_bf16 v[96:99], v[56:59], v[72:75], v[96:99]
    s_add_u32 s34, s34, 14336
    s_cmp_eq_u32 s34, 71680
    s_cselect_b32 s34, 0, s34
    v_mfma_f32_16x16x32_bf16 v[100:103], v[56:59], v[76:79], v[100:103]
    v_mfma_f32_16x16x32_bf16 v[104:107], v[60:63], v[68:71], v[104:107]
    v_mfma_f32_16x16x32_bf16 v[108:111], v[60:63], v[72:75], v[108:111]
    v_mfma_f32_16x16x32_bf16 v[112:115], v[60:63], v[76:79], v[112:115]
    v_mfma_f32_16x16x32_bf16 v[116:119], v[64:67], v[68:71], v[116:119]
    v_mfma_f32_16x16x32_bf16 v[120:123], v[64:67], v[72:75], v[120:123]
    v_mfma_f32_16x16x32_bf16 v[124:127], v[64:67], v[76:79], v[124:127]
    s_add_u32 s48, s48, 2
    s_cmp_lt_u32 s48, 62
    s_cbranch_scc1 G1_LOOP
    s_waitcnt lgkmcnt(0)
    s_barrier
    v_mfma_f32_16x16x32_bf16 v[80:83], v[24:27], v[40:43], v[80:83]
    v_add_u32 v17, s34, v10
    v_add_u32 v18, s34, v11
    v_add_u32 v19, s34, v12
    v_add_u32 v20, s34, v13
    v_add_u32 v21, s34, v14
    ds_read_b64_tr_b16 v[52:53], v17
    ds_read_b64_tr_b16 v[54:55], v17 offset:1024
    v_mfma_f32_16x16x32_bf16 v[84:87], v[24:27], v[44:47], v[84:87]
    ds_read_b64_tr_b16 v[56:57], v18
    ds_read_b64_tr_b16 v[58:59], v18 offset:1024
    ds_read_b64_tr_b16 v[60:61], v19
    ds_read_b64_tr_b16 v[62:63], v19 offset:1024
    v_mfma_f32_16x16x32_bf16 v[88:91], v[24:27], v[48:51], v[88:91]
    ds_read_b64_tr_b16 v[64:65], v20
    ds_read_b64_tr_b16 v[66:67], v20 offset:1024
    ds_read_b128 v[68:71], v21 offset:0
    v_mfma_f32_16x16x32_bf16 v[92:95], v[28:31], v[40:43], v[92:95]
    ds_read_b128 v[72:75], v21 offset:1024
    ds_read_b128 v[76:79], v21 offset:2048
    v_mfma_f32_16x16x32_bf16 v[96:99], v[28:31], v[44:47], v[96:99]
    s_add_u32 s34, s34, 14336
    s_cmp_eq_u32 s34, 71680
    s_cselect_b32 s34, 0, s34
    v_mfma_f32_16x16x32_bf16 v[100:103], v[28:31], v[48:51], v[100:103]
    v_mfma_f32_16x16x32_bf16 v[104:107], v[32:35], v[40:43], v[104:107]
    v_mfma_f32_16x16x32_bf16 v[108:111], v[32:35], v[44:47], v[108:111]
    v_mfma_f32_16x16x32_bf16 v[112:115], v[32:35], v[48:51], v[112:115]
    v_mfma_f32_16x16x32_bf16 v[116:119], v[36:39], v[40:43], v[116:119]
    v_mfma_f32_16x16x32_bf16 v[120:123], v[36:39], v[44:47], v[120:123]
    v_mfma_f32_16x16x32_bf16 v[124:127], v[36:39], v[48:51], v[124:127]
    s_waitcnt lgkmcnt(0)
    s_barrier
    v_mfma_f32_16x16x32_bf16 v[80:83], v[52:55], v[68:71], v[80:83]
    v_mfma_f32_16x16x32_bf16 v[84:87], v[52:55], v[72:75], v[84:87]
    v_mfma_f32_16x16x32_bf16 v[88:91], v[52:55], v[76:79], v[88:91]
    v_mfma_f32_16x16x32_bf16 v[92:95], v[56:59], v[68:71], v[92:95]
    v_mfma_f32_16x16x32_bf16 v[96:99], v[56:59], v[72:75], v[96:99]
    v_mfma_f32_16x16x32_bf16 v[100:103], v[56:59], v[76:79], v[100:103]
    v_mfma_f32_16x16x32_bf16 v[104:107], v[60:63], v[68:71], v[104:107]
    v_mfma_f32_16x16x32_bf16 v[108:111], v[60:63], v[72:75], v[108:111]
    v_mfma_f32_16x16x32_bf16 v[112:115], v[60:63], v[76:79], v[112:115]
    v_mfma_f32_16x16x32_bf16 v[116:119], v[64:67], v[68:71], v[116:119]
    v_mfma_f32_16x16x32_bf16 v[120:123], v[64:67], v[72:75], v[120:123]
    v_mfma_f32_16x16x32_bf16 v[124:127], v[64:67], v[76:79], v[124:127]
    s_lshl_b32 s44, s29, 8
    s_lshl_b32 s45, s46, 7
    s_add_u32 s44, s44, s45
    v_lshlrev_b32 v6, 3, v3
    v_add_u32 v6, s44, v6
    buffer_load_dwordx2 v[8:9], v6, s[24:27], 0 offen offset:0
    buffer_load_dwordx2 v[10:11], v6, s[24:27], 0 offen offset:32
    buffer_load_dwordx2 v[12:13], v6, s[24:27], 0 offen offset:64
    buffer_load_dwordx2 v[14:15], v6, s[24:27], 0 offen offset:96
    s_nop 15
    s_mov_b32 s50, 0xffff0000
    s_mov_b32 s51, 0x3d372713
    s_mov_b32 s52, 0xc0135761
    s_mul_i32 s44, s28, 6
    s_mul_i32 s45, s47, 3
    s_add_u32 s44, s44, s45
    s_mul_i32 s44, s44, 144
    s_lshl_b32 s45, s29, 2
    s_add_u32 s44, s44, s45
    s_lshl_b32 s45, s46, 1
    s_add_u32 s44, s44, s45
    s_lshl_b32 s44, s44, 10
    v_add_u32 v6, s44, v16
    s_waitcnt vmcnt(0)
    v_lshlrev_b32 v64, 16, v8
    v_and_b32 v65, s50, v8
    v_lshlrev_b32 v66, 16, v9
    v_and_b32 v67, s50, v9
    v_lshlrev_b32 v68, 16, v10
    v_and_b32 v69, s50, v10
    v_lshlrev_b32 v70, 16, v11
    v_and_b32 v71, s50, v11
    v_lshlrev_b32 v72, 16, v12
    v_and_b32 v73, s50, v12
    v_lshlrev_b32 v74, 16, v13
    v_and_b32 v75, s50, v13
    v_lshlrev_b32 v76, 16, v14
    v_and_b32 v77, s50, v14
    v_lshlrev_b32 v78, 16, v15
    v_and_b32 v79, s50, v15
    v_cvt_pk_bf16_f32 v24, v80, v81
    v_lshlrev_b32 v25, 16, v24
    v_and_b32 v26, s50, v24
    v_add_f32 v25, v25, v64
    v_add_f32 v26, v26, v65
    v_cvt_pk_bf16_f32 v24, v25, v26
    v_lshlrev_b32 v25, 16, v24
    v_and_b32 v26, s50, v24
    v_mul_f32 v27, v25, v25
    v_mul_f32 v28, v26, v26
    v_fma_f32 v27, v27, s51, 1.0
    v_fma_f32 v28, v28, s51, 1.0
    v_mul_f32 v27, v27, v25
    v_mul_f32 v28, v28, v26
    v_mul_f32 v27, s52, v27
    v_mul_f32 v28, s52, v28
    v_exp_f32 v27, v27
    v_exp_f32 v28, v28
    s_nop 0
    v_add_f32 v27, 1.0, v27
    v_add_f32 v28, 1.0, v28
    v_rcp_f32 v27, v27
    v_rcp_f32 v28, v28
    s_nop 0
    v_mul_f32 v27, v27, v25
    v_mul_f32 v28, v28, v26
    v_cvt_pk_bf16_f32 v32, v27, v28
    v_cvt_pk_bf16_f32 v24, v82, v83
    v_lshlrev_b32 v25, 16, v24
    v_and_b32 v26, s50, v24
    v_add_f32 v25, v25, v66
    v_add_f32 v26, v26, v67
    v_cvt_pk_bf16_f32 v24, v25, v26
    v_lshlrev_b32 v25, 16, v24
    v_and_b32 v26, s50, v24
    v_mul_f32 v27, v25, v25
    v_mul_f32 v28, v26, v26
    v_fma_f32 v27, v27, s51, 1.0
    v_fma_f32 v28, v28, s51, 1.0
    v_mul_f32 v27, v27, v25
    v_mul_f32 v28, v28, v26
    v_mul_f32 v27, s52, v27
    v_mul_f32 v28, s52, v28
    v_exp_f32 v27, v27
    v_exp_f32 v28, v28
    s_nop 0
    v_add_f32 v27, 1.0, v27
    v_add_f32 v28, 1.0, v28
    v_rcp_f32 v27, v27
    v_rcp_f32 v28, v28
    s_nop 0
    v_mul_f32 v27, v27, v25
    v_mul_f32 v28, v28, v26
    v_cvt_pk_bf16_f32 v33, v27, v28
    v_cvt_pk_bf16_f32 v24, v92, v93
    v_lshlrev_b32 v25, 16, v24
    v_and_b32 v26, s50, v24
    v_add_f32 v25, v25, v68
    v_add_f32 v26, v26, v69
    v_cvt_pk_bf16_f32 v24, v25, v26
    v_lshlrev_b32 v25, 16, v24
    v_and_b32 v26, s50, v24
    v_mul_f32 v27, v25, v25
    v_mul_f32 v28, v26, v26
    v_fma_f32 v27, v27, s51, 1.0
    v_fma_f32 v28, v28, s51, 1.0
    v_mul_f32 v27, v27, v25
    v_mul_f32 v28, v28, v26
    v_mul_f32 v27, s52, v27
    v_mul_f32 v28, s52, v28
    v_exp_f32 v27, v27
    v_exp_f32 v28, v28
    s_nop 0
    v_add_f32 v27, 1.0, v27
    v_add_f32 v28, 1.0, v28
    v_rcp_f32 v27, v27
    v_rcp_f32 v28, v28
    s_nop 0
    v_mul_f32 v27, v27, v25
    v_mul_f32 v28, v28, v26
    v_cvt_pk_bf16_f32 v34, v27, v28
    v_cvt_pk_bf16_f32 v24, v94, v95
    v_lshlrev_b32 v25, 16, v24
    v_and_b32 v26, s50, v24
    v_add_f32 v25, v25, v70
    v_add_f32 v26, v26, v71
    v_cvt_pk_bf16_f32 v24, v25, v26
    v_lshlrev_b32 v25, 16, v24
    v_and_b32 v26, s50, v24
    v_mul_f32 v27, v25, v25
    v_mul_f32 v28, v26, v26
    v_fma_f32 v27, v27, s51, 1.0
    v_fma_f32 v28, v28, s51, 1.0
    v_mul_f32 v27, v27, v25
    v_mul_f32 v28, v28, v26
    v_mul_f32 v27, s52, v27
    v_mul_f32 v28, s52, v28
    v_exp_f32 v27, v27
    v_exp_f32 v28, v28
    s_nop 0
    v_add_f32 v27, 1.0, v27
    v_add_f32 v28, 1.0, v28
    v_rcp_f32 v27, v27
    v_rcp_f32 v28, v28
    s_nop 0
    v_mul_f32 v27, v27, v25
    v_mul_f32 v28, v28, v26
    v_cvt_pk_bf16_f32 v35, v27, v28
    s_mov_b32 s44, 0
    buffer_store_dwordx4 v[32:35], v6, s[20:23], s44 offen
    v_cvt_pk_bf16_f32 v24, v84, v85
    v_lshlrev_b32 v25, 16, v24
    v_and_b32 v26, s50, v24
    v_add_f32 v25, v25, v64
    v_add_f32 v26, v26, v65
    v_cvt_pk_bf16_f32 v24, v25, v26
    v_lshlrev_b32 v25, 16, v24
    v_and_b32 v26, s50, v24
    v_mul_f32 v27, v25, v25
    v_mul_f32 v28, v26, v26
    v_fma_f32 v27, v27, s51, 1.0
    v_fma_f32 v28, v28, s51, 1.0
    v_mul_f32 v27, v27, v25
    v_mul_f32 v28, v28, v26
    v_mul_f32 v27, s52, v27
    v_mul_f32 v28, s52, v28
    v_exp_f32 v27, v27
    v_exp_f32 v28, v28
    s_nop 0
    v_add_f32 v27, 1.0, v27
    v_add_f32 v28, 1.0, v28
    v_rcp_f32 v27, v27
    v_rcp_f32 v28, v28
    s_nop 0
    v_mul_f32 v27, v27, v25
    v_mul_f32 v28, v28, v26
    v_cvt_pk_bf16_f32 v36, v27, v28
    v_cvt_pk_bf16_f32 v24, v86, v87
    v_lshlrev_b32 v25, 16, v24
    v_and_b32 v26, s50, v24
    v_add_f32 v25, v25, v66
    v_add_f32 v26, v26, v67
    v_cvt_pk_bf16_f32 v24, v25, v26
    v_lshlrev_b32 v25, 16, v24
    v_and_b32 v26, s50, v24
    v_mul_f32 v27, v25, v25
    v_mul_f32 v28, v26, v26
    v_fma_f32 v27, v27, s51, 1.0
    v_fma_f32 v28, v28, s51, 1.0
    v_mul_f32 v27, v27, v25
    v_mul_f32 v28, v28, v26
    v_mul_f32 v27, s52, v27
    v_mul_f32 v28, s52, v28
    v_exp_f32 v27, v27
    v_exp_f32 v28, v28
    s_nop 0
    v_add_f32 v27, 1.0, v27
    v_add_f32 v28, 1.0, v28
    v_rcp_f32 v27, v27
    v_rcp_f32 v28, v28
    s_nop 0
    v_mul_f32 v27, v27, v25
    v_mul_f32 v28, v28, v26
    v_cvt_pk_bf16_f32 v37, v27, v28
    v_cvt_pk_bf16_f32 v24, v96, v97
    v_lshlrev_b32 v25, 16, v24
    v_and_b32 v26, s50, v24
    v_add_f32 v25, v25, v68
    v_add_f32 v26, v26, v69
    v_cvt_pk_bf16_f32 v24, v25, v26
    v_lshlrev_b32 v25, 16, v24
    v_and_b32 v26, s50, v24
    v_mul_f32 v27, v25, v25
    v_mul_f32 v28, v26, v26
    v_fma_f32 v27, v27, s51, 1.0
    v_fma_f32 v28, v28, s51, 1.0
    v_mul_f32 v27, v27, v25
    v_mul_f32 v28, v28, v26
    v_mul_f32 v27, s52, v27
    v_mul_f32 v28, s52, v28
    v_exp_f32 v27, v27
    v_exp_f32 v28, v28
    s_nop 0
    v_add_f32 v27, 1.0, v27
    v_add_f32 v28, 1.0, v28
    v_rcp_f32 v27, v27
    v_rcp_f32 v28, v28
    s_nop 0
    v_mul_f32 v27, v27, v25
    v_mul_f32 v28, v28, v26
    v_cvt_pk_bf16_f32 v38, v27, v28
    v_cvt_pk_bf16_f32 v24, v98, v99
    v_lshlrev_b32 v25, 16, v24
    v_and_b32 v26, s50, v24
    v_add_f32 v25, v25, v70
    v_add_f32 v26, v26, v71
    v_cvt_pk_bf16_f32 v24, v25, v26
    v_lshlrev_b32 v25, 16, v24
    v_and_b32 v26, s50, v24
    v_mul_f32 v27, v25, v25
    v_mul_f32 v28, v26, v26
    v_fma_f32 v27, v27, s51, 1.0
    v_fma_f32 v28, v28, s51, 1.0
    v_mul_f32 v27, v27, v25
    v_mul_f32 v28, v28, v26
    v_mul_f32 v27, s52, v27
    v_mul_f32 v28, s52, v28
    v_exp_f32 v27, v27
    v_exp_f32 v28, v28
    s_nop 0
    v_add_f32 v27, 1.0, v27
    v_add_f32 v28, 1.0, v28
    v_rcp_f32 v27, v27
    v_rcp_f32 v28, v28
    s_nop 0
    v_mul_f32 v27, v27, v25
    v_mul_f32 v28, v28, v26
    v_cvt_pk_bf16_f32 v39, v27, v28
    s_mov_b32 s44, 147456
    buffer_store_dwordx4 v[36:39], v6, s[20:23], s44 offen
    v_cvt_pk_bf16_f32 v24, v88, v89
    v_lshlrev_b32 v25, 16, v24
    v_and_b32 v26, s50, v24
    v_add_f32 v25, v25, v64
    v_add_f32 v26, v26, v65
    v_cvt_pk_bf16_f32 v24, v25, v26
    v_lshlrev_b32 v25, 16, v24
    v_and_b32 v26, s50, v24
    v_mul_f32 v27, v25, v25
    v_mul_f32 v28, v26, v26
    v_fma_f32 v27, v27, s51, 1.0
    v_fma_f32 v28, v28, s51, 1.0
    v_mul_f32 v27, v27, v25
    v_mul_f32 v28, v28, v26
    v_mul_f32 v27, s52, v27
    v_mul_f32 v28, s52, v28
    v_exp_f32 v27, v27
    v_exp_f32 v28, v28
    s_nop 0
    v_add_f32 v27, 1.0, v27
    v_add_f32 v28, 1.0, v28
    v_rcp_f32 v27, v27
    v_rcp_f32 v28, v28
    s_nop 0
    v_mul_f32 v27, v27, v25
    v_mul_f32 v28, v28, v26
    v_cvt_pk_bf16_f32 v32, v27, v28
    v_cvt_pk_bf16_f32 v24, v90, v91
    v_lshlrev_b32 v25, 16, v24
    v_and_b32 v26, s50, v24
    v_add_f32 v25, v25, v66
    v_add_f32 v26, v26, v67
    v_cvt_pk_bf16_f32 v24, v25, v26
    v_lshlrev_b32 v25, 16, v24
    v_and_b32 v26, s50, v24
    v_mul_f32 v27, v25, v25
    v_mul_f32 v28, v26, v26
    v_fma_f32 v27, v27, s51, 1.0
    v_fma_f32 v28, v28, s51, 1.0
    v_mul_f32 v27, v27, v25
    v_mul_f32 v28, v28, v26
    v_mul_f32 v27, s52, v27
    v_mul_f32 v28, s52, v28
    v_exp_f32 v27, v27
    v_exp_f32 v28, v28
    s_nop 0
    v_add_f32 v27, 1.0, v27
    v_add_f32 v28, 1.0, v28
    v_rcp_f32 v27, v27
    v_rcp_f32 v28, v28
    s_nop 0
    v_mul_f32 v27, v27, v25
    v_mul_f32 v28, v28, v26
    v_cvt_pk_bf16_f32 v33, v27, v28
    v_cvt_pk_bf16_f32 v24, v100, v101
    v_lshlrev_b32 v25, 16, v24
    v_and_b32 v26, s50, v24
    v_add_f32 v25, v25, v68
    v_add_f32 v26, v26, v69
    v_cvt_pk_bf16_f32 v24, v25, v26
    v_lshlrev_b32 v25, 16, v24
    v_and_b32 v26, s50, v24
    v_mul_f32 v27, v25, v25
    v_mul_f32 v28, v26, v26
    v_fma_f32 v27, v27, s51, 1.0
    v_fma_f32 v28, v28, s51, 1.0
    v_mul_f32 v27, v27, v25
    v_mul_f32 v28, v28, v26
    v_mul_f32 v27, s52, v27
    v_mul_f32 v28, s52, v28
    v_exp_f32 v27, v27
    v_exp_f32 v28, v28
    s_nop 0
    v_add_f32 v27, 1.0, v27
    v_add_f32 v28, 1.0, v28
    v_rcp_f32 v27, v27
    v_rcp_f32 v28, v28
    s_nop 0
    v_mul_f32 v27, v27, v25
    v_mul_f32 v28, v28, v26
    v_cvt_pk_bf16_f32 v34, v27, v28
    v_cvt_pk_bf16_f32 v24, v102, v103
    v_lshlrev_b32 v25, 16, v24
    v_and_b32 v26, s50, v24
    v_add_f32 v25, v25, v70
    v_add_f32 v26, v26, v71
    v_cvt_pk_bf16_f32 v24, v25, v26
    v_lshlrev_b32 v25, 16, v24
    v_and_b32 v26, s50, v24
    v_mul_f32 v27, v25, v25
    v_mul_f32 v28, v26, v26
    v_fma_f32 v27, v27, s51, 1.0
    v_fma_f32 v28, v28, s51, 1.0
    v_mul_f32 v27, v27, v25
    v_mul_f32 v28, v28, v26
    v_mul_f32 v27, s52, v27
    v_mul_f32 v28, s52, v28
    v_exp_f32 v27, v27
    v_exp_f32 v28, v28
    s_nop 0
    v_add_f32 v27, 1.0, v27
    v_add_f32 v28, 1.0, v28
    v_rcp_f32 v27, v27
    v_rcp_f32 v28, v28
    s_nop 0
    v_mul_f32 v27, v27, v25
    v_mul_f32 v28, v28, v26
    v_cvt_pk_bf16_f32 v35, v27, v28
    s_mov_b32 s44, 294912
    buffer_store_dwordx4 v[32:35], v6, s[20:23], s44 offen
    v_cvt_pk_bf16_f32 v24, v104, v105
    v_lshlrev_b32 v25, 16, v24
    v_and_b32 v26, s50, v24
    v_add_f32 v25, v25, v72
    v_add_f32 v26, v26, v73
    v_cvt_pk_bf16_f32 v24, v25, v26
    v_lshlrev_b32 v25, 16, v24
    v_and_b32 v26, s50, v24
    v_mul_f32 v27, v25, v25
    v_mul_f32 v28, v26, v26
    v_fma_f32 v27, v27, s51, 1.0
    v_fma_f32 v28, v28, s51, 1.0
    v_mul_f32 v27, v27, v25
    v_mul_f32 v28, v28, v26
    v_mul_f32 v27, s52, v27
    v_mul_f32 v28, s52, v28
    v_exp_f32 v27, v27
    v_exp_f32 v28, v28
    s_nop 0
    v_add_f32 v27, 1.0, v27
    v_add_f32 v28, 1.0, v28
    v_rcp_f32 v27, v27
    v_rcp_f32 v28, v28
    s_nop 0
    v_mul_f32 v27, v27, v25
    v_mul_f32 v28, v28, v26
    v_cvt_pk_bf16_f32 v36, v27, v28
    v_cvt_pk_bf16_f32 v24, v106, v107
    v_lshlrev_b32 v25, 16, v24
    v_and_b32 v26, s50, v24
    v_add_f32 v25, v25, v74
    v_add_f32 v26, v26, v75
    v_cvt_pk_bf16_f32 v24, v25, v26
    v_lshlrev_b32 v25, 16, v24
    v_and_b32 v26, s50, v24
    v_mul_f32 v27, v25, v25
    v_mul_f32 v28, v26, v26
    v_fma_f32 v27, v27, s51, 1.0
    v_fma_f32 v28, v28, s51, 1.0
    v_mul_f32 v27, v27, v25
    v_mul_f32 v28, v28, v26
    v_mul_f32 v27, s52, v27
    v_mul_f32 v28, s52, v28
    v_exp_f32 v27, v27
    v_exp_f32 v28, v28
    s_nop 0
    v_add_f32 v27, 1.0, v27
    v_add_f32 v28, 1.0, v28
    v_rcp_f32 v27, v27
    v_rcp_f32 v28, v28
    s_nop 0
    v_mul_f32 v27, v27, v25
    v_mul_f32 v28, v28, v26
    v_cvt_pk_bf16_f32 v37, v27, v28
    v_cvt_pk_bf16_f32 v24, v116, v117
    v_lshlrev_b32 v25, 16, v24
    v_and_b32 v26, s50, v24
    v_add_f32 v25, v25, v76
    v_add_f32 v26, v26, v77
    v_cvt_pk_bf16_f32 v24, v25, v26
    v_lshlrev_b32 v25, 16, v24
    v_and_b32 v26, s50, v24
    v_mul_f32 v27, v25, v25
    v_mul_f32 v28, v26, v26
    v_fma_f32 v27, v27, s51, 1.0
    v_fma_f32 v28, v28, s51, 1.0
    v_mul_f32 v27, v27, v25
    v_mul_f32 v28, v28, v26
    v_mul_f32 v27, s52, v27
    v_mul_f32 v28, s52, v28
    v_exp_f32 v27, v27
    v_exp_f32 v28, v28
    s_nop 0
    v_add_f32 v27, 1.0, v27
    v_add_f32 v28, 1.0, v28
    v_rcp_f32 v27, v27
    v_rcp_f32 v28, v28
    s_nop 0
    v_mul_f32 v27, v27, v25
    v_mul_f32 v28, v28, v26
    v_cvt_pk_bf16_f32 v38, v27, v28
    v_cvt_pk_bf16_f32 v24, v118, v119
    v_lshlrev_b32 v25, 16, v24
    v_and_b32 v26, s50, v24
    v_add_f32 v25, v25, v78
    v_add_f32 v26, v26, v79
    v_cvt_pk_bf16_f32 v24, v25, v26
    v_lshlrev_b32 v25, 16, v24
    v_and_b32 v26, s50, v24
    v_mul_f32 v27, v25, v25
    v_mul_f32 v28, v26, v26
    v_fma_f32 v27, v27, s51, 1.0
    v_fma_f32 v28, v28, s51, 1.0
    v_mul_f32 v27, v27, v25
    v_mul_f32 v28, v28, v26
    v_mul_f32 v27, s52, v27
    v_mul_f32 v28, s52, v28
    v_exp_f32 v27, v27
    v_exp_f32 v28, v28
    s_nop 0
    v_add_f32 v27, 1.0, v27
    v_add_f32 v28, 1.0, v28
    v_rcp_f32 v27, v27
    v_rcp_f32 v28, v28
    s_nop 0
    v_mul_f32 v27, v27, v25
    v_mul_f32 v28, v28, v26
    v_cvt_pk_bf16_f32 v39, v27, v28
    s_mov_b32 s44, 1024
    buffer_store_dwordx4 v[36:39], v6, s[20:23], s44 offen
    v_cvt_pk_bf16_f32 v24, v108, v109
    v_lshlrev_b32 v25, 16, v24
    v_and_b32 v26, s50, v24
    v_add_f32 v25, v25, v72
    v_add_f32 v26, v26, v73
    v_cvt_pk_bf16_f32 v24, v25, v26
    v_lshlrev_b32 v25, 16, v24
    v_and_b32 v26, s50, v24
    v_mul_f32 v27, v25, v25
    v_mul_f32 v28, v26, v26
    v_fma_f32 v27, v27, s51, 1.0
    v_fma_f32 v28, v28, s51, 1.0
    v_mul_f32 v27, v27, v25
    v_mul_f32 v28, v28, v26
    v_mul_f32 v27, s52, v27
    v_mul_f32 v28, s52, v28
    v_exp_f32 v27, v27
    v_exp_f32 v28, v28
    s_nop 0
    v_add_f32 v27, 1.0, v27
    v_add_f32 v28, 1.0, v28
    v_rcp_f32 v27, v27
    v_rcp_f32 v28, v28
    s_nop 0
    v_mul_f32 v27, v27, v25
    v_mul_f32 v28, v28, v26
    v_cvt_pk_bf16_f32 v32, v27, v28
    v_cvt_pk_bf16_f32 v24, v110, v111
    v_lshlrev_b32 v25, 16, v24
    v_and_b32 v26, s50, v24
    v_add_f32 v25, v25, v74
    v_add_f32 v26, v26, v75
    v_cvt_pk_bf16_f32 v24, v25, v26
    v_lshlrev_b32 v25, 16, v24
    v_and_b32 v26, s50, v24
    v_mul_f32 v27, v25, v25
    v_mul_f32 v28, v26, v26
    v_fma_f32 v27, v27, s51, 1.0
    v_fma_f32 v28, v28, s51, 1.0
    v_mul_f32 v27, v27, v25
    v_mul_f32 v28, v28, v26
    v_mul_f32 v27, s52, v27
    v_mul_f32 v28, s52, v28
    v_exp_f32 v27, v27
    v_exp_f32 v28, v28
    s_nop 0
    v_add_f32 v27, 1.0, v27
    v_add_f32 v28, 1.0, v28
    v_rcp_f32 v27, v27
    v_rcp_f32 v28, v28
    s_nop 0
    v_mul_f32 v27, v27, v25
    v_mul_f32 v28, v28, v26
    v_cvt_pk_bf16_f32 v33, v27, v28
    v_cvt_pk_bf16_f32 v24, v120, v121
    v_lshlrev_b32 v25, 16, v24
    v_and_b32 v26, s50, v24
    v_add_f32 v25, v25, v76
    v_add_f32 v26, v26, v77
    v_cvt_pk_bf16_f32 v24, v25, v26
    v_lshlrev_b32 v25, 16, v24
    v_and_b32 v26, s50, v24
    v_mul_f32 v27, v25, v25
    v_mul_f32 v28, v26, v26
    v_fma_f32 v27, v27, s51, 1.0
    v_fma_f32 v28, v28, s51, 1.0
    v_mul_f32 v27, v27, v25
    v_mul_f32 v28, v28, v26
    v_mul_f32 v27, s52, v27
    v_mul_f32 v28, s52, v28
    v_exp_f32 v27, v27
    v_exp_f32 v28, v28
    s_nop 0
    v_add_f32 v27, 1.0, v27
    v_add_f32 v28, 1.0, v28
    v_rcp_f32 v27, v27
    v_rcp_f32 v28, v28
    s_nop 0
    v_mul_f32 v27, v27, v25
    v_mul_f32 v28, v28, v26
    v_cvt_pk_bf16_f32 v34, v27, v28
    v_cvt_pk_bf16_f32 v24, v122, v123
    v_lshlrev_b32 v25, 16, v24
    v_and_b32 v26, s50, v24
    v_add_f32 v25, v25, v78
    v_add_f32 v26, v26, v79
    v_cvt_pk_bf16_f32 v24, v25, v26
    v_lshlrev_b32 v25, 16, v24
    v_and_b32 v26, s50, v24
    v_mul_f32 v27, v25, v25
    v_mul_f32 v28, v26, v26
    v_fma_f32 v27, v27, s51, 1.0
    v_fma_f32 v28, v28, s51, 1.0
    v_mul_f32 v27, v27, v25
    v_mul_f32 v28, v28, v26
    v_mul_f32 v27, s52, v27
    v_mul_f32 v28, s52, v28
    v_exp_f32 v27, v27
    v_exp_f32 v28, v28
    s_nop 0
    v_add_f32 v27, 1.0, v27
    v_add_f32 v28, 1.0, v28
    v_rcp_f32 v27, v27
    v_rcp_f32 v28, v28
    s_nop 0
    v_mul_f32 v27, v27, v25
    v_mul_f32 v28, v28, v26
    v_cvt_pk_bf16_f32 v35, v27, v28
    s_mov_b32 s44, 148480
    buffer_store_dwordx4 v[32:35], v6, s[20:23], s44 offen
    v_cvt_pk_bf16_f32 v24, v112, v113
    v_lshlrev_b32 v25, 16, v24
    v_and_b32 v26, s50, v24
    v_add_f32 v25, v25, v72
    v_add_f32 v26, v26, v73
    v_cvt_pk_bf16_f32 v24, v25, v26
    v_lshlrev_b32 v25, 16, v24
    v_and_b32 v26, s50, v24
    v_mul_f32 v27, v25, v25
    v_mul_f32 v28, v26, v26
    v_fma_f32 v27, v27, s51, 1.0
    v_fma_f32 v28, v28, s51, 1.0
    v_mul_f32 v27, v27, v25
    v_mul_f32 v28, v28, v26
    v_mul_f32 v27, s52, v27
    v_mul_f32 v28, s52, v28
    v_exp_f32 v27, v27
    v_exp_f32 v28, v28
    s_nop 0
    v_add_f32 v27, 1.0, v27
    v_add_f32 v28, 1.0, v28
    v_rcp_f32 v27, v27
    v_rcp_f32 v28, v28
    s_nop 0
    v_mul_f32 v27, v27, v25
    v_mul_f32 v28, v28, v26
    v_cvt_pk_bf16_f32 v36, v27, v28
    v_cvt_pk_bf16_f32 v24, v114, v115
    v_lshlrev_b32 v25, 16, v24
    v_and_b32 v26, s50, v24
    v_add_f32 v25, v25, v74
    v_add_f32 v26, v26, v75
    v_cvt_pk_bf16_f32 v24, v25, v26
    v_lshlrev_b32 v25, 16, v24
    v_and_b32 v26, s50, v24
    v_mul_f32 v27, v25, v25
    v_mul_f32 v28, v26, v26
    v_fma_f32 v27, v27, s51, 1.0
    v_fma_f32 v28, v28, s51, 1.0
    v_mul_f32 v27, v27, v25
    v_mul_f32 v28, v28, v26
    v_mul_f32 v27, s52, v27
    v_mul_f32 v28, s52, v28
    v_exp_f32 v27, v27
    v_exp_f32 v28, v28
    s_nop 0
    v_add_f32 v27, 1.0, v27
    v_add_f32 v28, 1.0, v28
    v_rcp_f32 v27, v27
    v_rcp_f32 v28, v28
    s_nop 0
    v_mul_f32 v27, v27, v25
    v_mul_f32 v28, v28, v26
    v_cvt_pk_bf16_f32 v37, v27, v28
    v_cvt_pk_bf16_f32 v24, v124, v125
    v_lshlrev_b32 v25, 16, v24
    v_and_b32 v26, s50, v24
    v_add_f32 v25, v25, v76
    v_add_f32 v26, v26, v77
    v_cvt_pk_bf16_f32 v24, v25, v26
    v_lshlrev_b32 v25, 16, v24
    v_and_b32 v26, s50, v24
    v_mul_f32 v27, v25, v25
    v_mul_f32 v28, v26, v26
    v_fma_f32 v27, v27, s51, 1.0
    v_fma_f32 v28, v28, s51, 1.0
    v_mul_f32 v27, v27, v25
    v_mul_f32 v28, v28, v26
    v_mul_f32 v27, s52, v27
    v_mul_f32 v28, s52, v28
    v_exp_f32 v27, v27
    v_exp_f32 v28, v28
    s_nop 0
    v_add_f32 v27, 1.0, v27
    v_add_f32 v28, 1.0, v28
    v_rcp_f32 v27, v27
    v_rcp_f32 v28, v28
    s_nop 0
    v_mul_f32 v27, v27, v25
    v_mul_f32 v28, v28, v26
    v_cvt_pk_bf16_f32 v38, v27, v28
    v_cvt_pk_bf16_f32 v24, v126, v127
    v_lshlrev_b32 v25, 16, v24
    v_and_b32 v26, s50, v24
    v_add_f32 v25, v25, v78
    v_add_f32 v26, v26, v79
    v_cvt_pk_bf16_f32 v24, v25, v26
    v_lshlrev_b32 v25, 16, v24
    v_and_b32 v26, s50, v24
    v_mul_f32 v27, v25, v25
    v_mul_f32 v28, v26, v26
    v_fma_f32 v27, v27, s51, 1.0
    v_fma_f32 v28, v28, s51, 1.0
    v_mul_f32 v27, v27, v25
    v_mul_f32 v28, v28, v26
    v_mul_f32 v27, s52, v27
    v_mul_f32 v28, s52, v28
    v_exp_f32 v27, v27
    v_exp_f32 v28, v28
    s_nop 0
    v_add_f32 v27, 1.0, v27
    v_add_f32 v28, 1.0, v28
    v_rcp_f32 v27, v27
    v_rcp_f32 v28, v28
    s_nop 0
    v_mul_f32 v27, v27, v25
    v_mul_f32 v28, v28, v26
    v_cvt_pk_bf16_f32 v39, v27, v28
    s_mov_b32 s44, 295936
    buffer_store_dwordx4 v[36:39], v6, s[20:23], s44 offen
    s_endpgm
G1_PROD:
    s_add_u32 s44, s33, s39
    s_mov_b32 m0, s44
    s_add_u32 s45, s35, 36864
    buffer_load_dwordx4 v15, s[12:15], s35 offen lds
    s_add_u32 m0, s44, 1024
    s_nop 0
    buffer_load_dwordx4 v15, s[12:15], s45 offen lds
    s_add_u32 s44, s33, s40
    s_mov_b32 m0, s44
    s_add_u32 s45, s36, s38
    buffer_load_dwordx4 v16, s[16:19], s45 offen lds
    s_cmp_eq_u32 s42, 1
    s_cbranch_scc0 G1SK_1
    s_add_u32 m0, s44, 1024
    s_add_u32 s45, s45, 65536
    buffer_load_dwordx4 v16, s[16:19], s45 offen lds
G1SK_1:
    s_add_u32 s35, s35, 294912
    s_add_u32 s38, s38, 1024
    s_add_u32 s33, s33, 14336
    s_cmp_eq_u32 s33, 71680
    s_cselect_b32 s33, 0, s33
    s_add_u32 s44, s33, s39
    s_mov_b32 m0, s44
    s_add_u32 s45, s35, 36864
    buffer_load_dwordx4 v15, s[12:15], s35 offen lds
    s_add_u32 m0, s44, 1024
    s_nop 0
    buffer_load_dwordx4 v15, s[12:15], s45 offen lds
    s_add_u32 s44, s33, s41
    s_mov_b32 m0, s44
    s_add_u32 s45, s37, s38
    buffer_load_dwordx4 v16, s[16:19], s45 offen lds
    s_cmp_eq_u32 s42, 0
    s_cbranch_scc0 G1SK_2
    s_add_u32 m0, s44, 1024
    s_add_u32 s45, s45, 65536
    buffer_load_dwordx4 v16, s[16:19], s45 offen lds
G1SK_2:
    s_add_u32 s35, s35, 294912
    s_add_u32 s38, s38, 1024
    s_add_u32 s33, s33, 14336
    s_cmp_eq_u32 s33, 71680
    s_cselect_b32 s33, 0, s33
    s_add_u32 s44, s33, s39
    s_mov_b32 m0, s44
    s_add_u32 s45, s35, 36864
    buffer_load_dwordx4 v15, s[12:15], s35 offen lds
    s_add_u32 m0, s44, 1024
    s_nop 0
    buffer_load_dwordx4 v15, s[12:15], s45 offen lds
    s_add_u32 s44, s33, s40
    s_mov_b32 m0, s44
    s_add_u32 s45, s36, s38
    buffer_load_dwordx4 v16, s[16:19], s45 offen lds
    s_cmp_eq_u32 s42, 1
    s_cbranch_scc0 G1SK_3
    s_add_u32 m0, s44, 1024
    s_add_u32 s45, s45, 65536
    buffer_load_dwordx4 v16, s[16:19], s45 offen lds
G1SK_3:
    s_add_u32 s35, s35, 294912
    s_add_u32 s38, s38, 1024
    s_add_u32 s33, s33, 14336
    s_cmp_eq_u32 s33, 71680
    s_cselect_b32 s33, 0, s33
    s_add_u32 s44, s33, s39
    s_mov_b32 m0, s44
    s_add_u32 s45, s35, 36864
    buffer_load_dwordx4 v15, s[12:15], s35 offen lds
    s_add_u32 m0, s44, 1024
    s_nop 0
    buffer_load_dwordx4 v15, s[12:15], s45 offen lds
    s_add_u32 s44, s33, s41
    s_mov_b32 m0, s44
    s_add_u32 s45, s37, s38
    buffer_load_dwordx4 v16, s[16:19], s45 offen lds
    s_cmp_eq_u32 s42, 0
    s_cbranch_scc0 G1SK_4
    s_add_u32 m0, s44, 1024
    s_add_u32 s45, s45, 65536
    buffer_load_dwordx4 v16, s[16:19], s45 offen lds
G1SK_4:
    s_add_u32 s35, s35, 294912
    s_add_u32 s38, s38, 1024
    s_add_u32 s33, s33, 14336
    s_cmp_eq_u32 s33, 71680
    s_cselect_b32 s33, 0, s33
    s_add_u32 s44, s33, s39
    s_mov_b32 m0, s44
    s_add_u32 s45, s35, 36864
    buffer_load_dwordx4 v15, s[12:15], s35 offen lds
    s_add_u32 m0, s44, 1024
    s_nop 0
    buffer_load_dwordx4 v15, s[12:15], s45 offen lds
    s_add_u32 s44, s33, s40
    s_mov_b32 m0, s44
    s_add_u32 s45, s36, s38
    buffer_load_dwordx4 v16, s[16:19], s45 offen lds
    s_cmp_eq_u32 s42, 1
    s_cbranch_scc0 G1SK_5
    s_add_u32 m0, s44, 1024
    s_add_u32 s45, s45, 65536
    buffer_load_dwordx4 v16, s[16:19], s45 offen lds
G1SK_5:
    s_add_u32 s35, s35, 294912
    s_add_u32 s38, s38, 1024
    s_add_u32 s33, s33, 14336
    s_cmp_eq_u32 s33, 71680
    s_cselect_b32 s33, 0, s33
    s_waitcnt vmcnt(14)
    s_barrier
    s_mov_b32 s48, 0
G1_PLOOP:
    s_waitcnt vmcnt(10)
    s_barrier
    s_add_u32 s44, s33, s39
    s_mov_b32 m0, s44
    s_add_u32 s45, s35, 36864
    buffer_load_dwordx4 v15, s[12:15], s35 offen lds
    s_add_u32 m0, s44, 1024
    s_nop 0
    buffer_load_dwordx4 v15, s[12:15], s45 offen lds
    s_add_u32 s44, s33, s41
    s_mov_b32 m0, s44
    s_add_u32 s45, s37, s38
    buffer_load_dwordx4 v16, s[16:19], s45 offen lds
    s_cmp_eq_u32 s42, 0
    s_cbranch_scc0 G1SK_6
    s_add_u32 m0, s44, 1024
    s_add_u32 s45, s45, 65536
    buffer_load_dwordx4 v16, s[16:19], s45 offen lds
G1SK_6:
    s_add_u32 s35, s35, 294912
    s_add_u32 s38, s38, 1024
    s_add_u32 s33, s33, 14336
    s_cmp_eq_u32 s33, 71680
    s_cselect_b32 s33, 0, s33
    s_waitcnt vmcnt(10)
    s_barrier
    s_add_u32 s44, s33, s39
    s_mov_b32 m0, s44
    s_add_u32 s45, s35, 36864
    buffer_load_dwordx4 v15, s[12:15], s35 offen lds
    s_add_u32 m0, s44, 1024
    s_nop 0
    buffer_load_dwordx4 v15, s[12:15], s45 offen lds
    s_add_u32 s44, s33, s40
    s_mov_b32 m0, s44
    s_add_u32 s45, s36, s38
    buffer_load_dwordx4 v16, s[16:19], s45 offen lds
    s_cmp_eq_u32 s42, 1
    s_cbranch_scc0 G1SK_7
    s_add_u32 m0, s44, 1024
    s_add_u32 s45, s45, 65536
    buffer_load_dwordx4 v16, s[16:19], s45 offen lds
G1SK_7:
    s_add_u32 s35, s35, 294912
    s_add_u32 s38, s38, 1024
    s_add_u32 s33, s33, 14336
    s_cmp_eq_u32 s33, 71680
    s_cselect_b32 s33, 0, s33
    s_add_u32 s48, s48, 2
    s_cmp_lt_u32 s48, 58
    s_cbranch_scc1 G1_PLOOP
    s_waitcnt vmcnt(10)
    s_barrier
    s_add_u32 s44, s33, s39
    s_mov_b32 m0, s44
    s_add_u32 s45, s35, 36864
    buffer_load_dwordx4 v15, s[12:15], s35 offen lds
    s_add_u32 m0, s44, 1024
    s_nop 0
    buffer_load_dwordx4 v15, s[12:15], s45 offen lds
    s_add_u32 s44, s33, s41
    s_mov_b32 m0, s44
    s_add_u32 s45, s37, s38
    buffer_load_dwordx4 v16, s[16:19], s45 offen lds
    s_cmp_eq_u32 s42, 0
    s_cbranch_scc0 G1SK_8
    s_add_u32 m0, s44, 1024
    s_add_u32 s45, s45, 65536
    buffer_load_dwordx4 v16, s[16:19], s45 offen lds
G1SK_8:
    s_add_u32 s35, s35, 294912
    s_add_u32 s38, s38, 1024
    s_add_u32 s33, s33, 14336
    s_cmp_eq_u32 s33, 71680
    s_cselect_b32 s33, 0, s33
    s_waitcnt vmcnt(0)
    s_barrier
    s_waitcnt vmcnt(0)
    s_barrier
    s_waitcnt vmcnt(0)
    s_barrier
    s_waitcnt vmcnt(0)
    s_barrier
    s_waitcnt vmcnt(0)
    s_barrier
    s_endpgm
CONV_START:
    s_load_dwordx8 s[4:11], s[0:1], 8
    s_load_dwordx2 s[12:13], s[0:1], 40
    s_load_dwordx2 s[14:15], s[0:1], 120
    s_sub_u32 s20, s2, 216
    v_and_b32 v1, 63, v0
    v_lshrrev_b32 v2, 6, v0
    v_and_b32 v3, 15, v1
    v_lshrrev_b32 v4, 4, v1
    v_lshlrev_b32 v5, 5, v2
    v_lshl_add_u32 v5, v4, 3, v5
    s_lshl_b32 s21, s20, 8
    v_add_u32 v5, s21, v5
    s_lshl_b32 s22, s20, 1
    v_mov_b32 v6, s22
    s_waitcnt lgkmcnt(0)
    s_mov_b32 s24, s4
    s_and_b32 s25, s5, 0xffff
    s_mov_b32 s26, 147456
    s_mov_b32 s27, 0x00020000
    s_mov_b32 s28, s6
    s_and_b32 s29, s7, 0xffff
    s_mov_b32 s30, 147456
    s_mov_b32 s31, 0x00020000
    s_mov_b32 s32, s8
    s_and_b32 s33, s9, 0xffff
    s_mov_b32 s34, 147456
    s_mov_b32 s35, 0x00020000
    s_mov_b32 s36, s10
    s_and_b32 s37, s11, 0xffff
    s_mov_b32 s38, 147456
    s_mov_b32 s39, 0x00020000
    s_mov_b32 s40, s12
    s_and_b32 s41, s13, 0xffff
    s_mov_b32 s42, 1152
    s_mov_b32 s43, 0x00020000
    s_add_u32 s64, s14, 2359296
    s_addc_u32 s65, s15, 0
    s_and_b32 s65, s65, 0xffff
    s_mov_b32 s66, 2359296
    s_mov_b32 s67, 0x00020000
    s_add_u32 s68, s14, 4718592
    s_addc_u32 s69, s15, 0
    s_and_b32 s69, s69, 0xffff
    s_mov_b32 s70, 2359296
    s_mov_b32 s71, 0x00020000
    v_readfirstlane_b32 s62, v2
    s_cmp_lt_u32 s62, 4
    s_cbranch_scc0 KG_NOU
    v_lshlrev_b32 v16, 4, v1
    s_lshl_b32 s44, s62, 10
    s_add_u32 s45, s44, 32
    s_mov_b32 m0, s45
    s_lshl_b32 s46, s20, 12
    s_add_u32 s46, s46, s44
    buffer_load_dwordx4 v16, s[64:67], s46 offen lds
    v_mov_b32 v11, 0
    v_lshlrev_b32 v12, 2, v0
    v_cmp_gt_u32 vcc, 8, v0
    s_and_saveexec_b64 s[48:49], vcc
    ds_write_b32 v12, v11
    s_mov_b64 exec, s[48:49]
KG_NOU:
    buffer_load_dwordx2 v[16:17], v5, s[24:27], 0 offen
    buffer_load_dwordx2 v[20:21], v5, s[28:31], 0 offen
    buffer_load_dwordx2 v[24:25], v5, s[32:35], 0 offen
    buffer_load_dwordx2 v[28:29], v5, s[36:39], 0 offen
    buffer_load_ushort v7, v6, s[40:43], 0 offen
    v_lshlrev_b32 v8, 4, v3
    v_cvt_f32_u32 v8, v8
    v_cmp_gt_u32 vcc, 8, v3
    v_mov_b32 v9, 16
    s_nop 0
    v_cndmask_b32 v9, v3, v9, vcc
    v_lshlrev_b32 v9, 5, v9
    v_cvt_f32_u32 v9, v9
    v_cvt_f32_u32 v10, v3
    v_mov_b32 v96, 0
    v_mov_b32 v97, 0
    v_mov_b32 v98, 0
    v_mov_b32 v99, 0
    v_mov_b32 v100, 0
    v_mov_b32 v101, 0
    v_mov_b32 v102, 0
    v_mov_b32 v103, 0
    v_mov_b32 v104, 0
    v_mov_b32 v105, 0
    v_mov_b32 v106, 0
    v_mov_b32 v107, 0
    v_mov_b32 v108, 0
    v_mov_b32 v109, 0
    v_mov_b32 v110, 0
    v_mov_b32 v111, 0
    v_lshlrev_b32 v11, 3, v0
    v_sub_u32 v11, 2047, v11
    v_cvt_f32_u32 v11, v11
    v_cvt_pk_bf16_f32 v12, v11, v11
    v_lshlrev_b32 v12, 16, v12
    v_cvt_u32_f32 v13, v12
    v_lshrrev_b32 v12, 23, v12
    v_subrev_u32 v12, 134, v12
    v_max_i32 v12, 0, v12
    v_lshrrev_b32 v13, v12, v13
    v_lshl_add_u32 v13, v12, 7, v13
    v_lshlrev_b32 v112, 2, v13
    v_lshlrev_b32 v11, 3, v0
    v_sub_u32 v11, 2046, v11
    v_cvt_f32_u32 v11, v11
    v_cvt_pk_bf16_f32 v12, v11, v11
    v_lshlrev_b32 v12, 16, v12
    v_cvt_u32_f32 v13, v12
    v_lshrrev_b32 v12, 23, v12
    v_subrev_u32 v12, 134, v12
    v_max_i32 v12, 0, v12
    v_lshrrev_b32 v13, v12, v13
    v_lshl_add_u32 v13, v12, 7, v13
    v_lshlrev_b32 v113, 2, v13
    v_lshlrev_b32 v11, 3, v0
    v_sub_u32 v11, 2045, v11
    v_cvt_f32_u32 v11, v11
    v_cvt_pk_bf16_f32 v12, v11, v11
    v_lshlrev_b32 v12, 16, v12
    v_cvt_u32_f32 v13, v12
    v_lshrrev_b32 v12, 23, v12
    v_subrev_u32 v12, 134, v12
    v_max_i32 v12, 0, v12
    v_lshrrev_b32 v13, v12, v13
    v_lshl_add_u32 v13, v12, 7, v13
    v_lshlrev_b32 v114, 2, v13
    v_lshlrev_b32 v11, 3, v0
    v_sub_u32 v11, 2044, v11
    v_cvt_f32_u32 v11, v11
    v_cvt_pk_bf16_f32 v12, v11, v11
    v_lshlrev_b32 v12, 16, v12
    v_cvt_u32_f32 v13, v12
    v_lshrrev_b32 v12, 23, v12
    v_subrev_u32 v12, 134, v12
    v_max_i32 v12, 0, v12
    v_lshrrev_b32 v13, v12, v13
    v_lshl_add_u32 v13, v12, 7, v13
    v_lshlrev_b32 v115, 2, v13
    v_lshlrev_b32 v11, 3, v0
    v_sub_u32 v11, 2043, v11
    v_cvt_f32_u32 v11, v11
    v_cvt_pk_bf16_f32 v12, v11, v11
    v_lshlrev_b32 v12, 16, v12
    v_cvt_u32_f32 v13, v12
    v_lshrrev_b32 v12, 23, v12
    v_subrev_u32 v12, 134, v12
    v_max_i32 v12, 0, v12
    v_lshrrev_b32 v13, v12, v13
    v_lshl_add_u32 v13, v12, 7, v13
    v_lshlrev_b32 v116, 2, v13
    v_lshlrev_b32 v11, 3, v0
    v_sub_u32 v11, 2042, v11
    v_cvt_f32_u32 v11, v11
    v_cvt_pk_bf16_f32 v12, v11, v11
    v_lshlrev_b32 v12, 16, v12
    v_cvt_u32_f32 v13, v12
    v_lshrrev_b32 v12, 23, v12
    v_subrev_u32 v12, 134, v12
    v_max_i32 v12, 0, v12
    v_lshrrev_b32 v13, v12, v13
    v_lshl_add_u32 v13, v12, 7, v13
    v_lshlrev_b32 v117, 2, v13
    v_lshlrev_b32 v11, 3, v0
    v_sub_u32 v11, 2041, v11
    v_cvt_f32_u32 v11, v11
    v_cvt_pk_bf16_f32 v12, v11, v11
    v_lshlrev_b32 v12, 16, v12
    v_cvt_u32_f32 v13, v12
    v_lshrrev_b32 v12, 23, v12
    v_subrev_u32 v12, 134, v12
    v_max_i32 v12, 0, v12
    v_lshrrev_b32 v13, v12, v13
    v_lshl_add_u32 v13, v12, 7, v13
    v_lshlrev_b32 v118, 2, v13
    v_lshlrev_b32 v11, 3, v0
    v_sub_u32 v11, 2040, v11
    v_cvt_f32_u32 v11, v11
    v_cvt_pk_bf16_f32 v12, v11, v11
    v_lshlrev_b32 v12, 16, v12
    v_cvt_u32_f32 v13, v12
    v_lshrrev_b32 v12, 23, v12
    v_subrev_u32 v12, 134, v12
    v_max_i32 v12, 0, v12
    v_lshrrev_b32 v13, v12, v13
    v_lshl_add_u32 v13, v12, 7, v13
    v_lshlrev_b32 v119, 2, v13
    s_mov_b32 s72, 0xffff0000
    s_waitcnt vmcnt(0)
    v_lshlrev_b32 v7, 16, v7
    v_mul_f32 v7, 0x3fb8aa3b, v7
    v_exp_f32 v7, v7
    s_nop 0
    v_cvt_pk_bf16_f32 v7, v7, v7
    v_lshlrev_b32 v7, 16, v7
    v_lshlrev_b32 v32, 16, v16
    v_lshlrev_b32 v33, 16, v20
    v_lshlrev_b32 v34, 16, v24
    v_lshlrev_b32 v35, 16, v28
    v_mul_f32 v32, 0x3fb8aa3b, v32
    v_exp_f32 v32, v32
    s_nop 0
    v_cvt_pk_bf16_f32 v32, v32, v32
    v_lshlrev_b32 v32, 16, v32
    v_mul_f32 v32, v32, v7
    v_mul_f32 v32, 0xbfb8aa3b, v32
    v_mul_f32 v33, v33, v7
    v_mul_f32 v33, 0x3e22f983, v33
    v_mul_f32 v34, v34, v7
    v_mul_f32 v35, v35, v7
    v_mul_f32 v36, v32, v8
    v_mul_f32 v37, v33, v8
    v_exp_f32 v36, v36
    v_fract_f32 v37, v37
    v_cos_f32 v40, v37
    v_sin_f32 v41, v37
    s_nop 0
    v_mul_f32 v40, v40, v36
    v_mul_f32 v41, v41, v36
    v_mul_f32 v38, v32, v9
    v_mul_f32 v39, v33, v9
    v_exp_f32 v38, v38
    v_fract_f32 v39, v39
    v_cos_f32 v42, v39
    v_sin_f32 v43, v39
    s_nop 0
    v_mul_f32 v42, v42, v38
    v_mul_f32 v43, v43, v38
    v_mul_f32 v36, v32, v10
    v_mul_f32 v37, v33, v10
    v_exp_f32 v36, v36
    v_fract_f32 v37, v37
    v_cos_f32 v44, v37
    v_sin_f32 v45, v37
    s_nop 0
    v_mul_f32 v44, v44, v36
    v_mul_f32 v45, v45, v36
    v_mul_f32 v36, v35, v41
    v_mul_f32 v37, v35, v40
    v_fma_f32 v46, v34, v40, -v36
    v_fma_f32 v47, -v34, v41, -v37
    s_nop 1
    v_mfma_f32_16x16x4_f32 v[96:99], v46, v44, v[96:99]
    v_mfma_f32_16x16x4_f32 v[96:99], v47, v45, v[96:99]
    v_mul_f32 v36, v45, v45
    v_add_f32 v37, v44, v44
    v_fma_f32 v44, v44, v44, -v36
    v_mul_f32 v45, v37, v45
    v_mul_f32 v36, v35, v43
    v_mul_f32 v37, v35, v42
    v_fma_f32 v48, v34, v42, -v36
    v_fma_f32 v49, -v34, v43, -v37
    v_mov_b32 v58, v44
    v_mov_b32 v59, v45
    s_nop 1
    v_mfma_f32_16x16x4_f32 v[100:103], v48, v58, v[100:103]
    v_mfma_f32_16x16x4_f32 v[100:103], v49, v59, v[100:103]
    v_mul_f32 v36, v45, v45
    v_add_f32 v37, v44, v44
    v_fma_f32 v44, v44, v44, -v36
    v_mul_f32 v45, v37, v45
    v_mul_f32 v38, v43, v43
    v_add_f32 v39, v42, v42
    v_fma_f32 v42, v42, v42, -v38
    v_mul_f32 v43, v39, v43
    v_mul_f32 v36, v35, v43
    v_mul_f32 v37, v35, v42
    v_fma_f32 v50, v34, v42, -v36
    v_fma_f32 v51, -v34, v43, -v37
    v_mov_b32 v60, v44
    v_mov_b32 v61, v45
    s_nop 1
    v_mfma_f32_16x16x4_f32 v[104:107], v50, v60, v[104:107]
    v_mfma_f32_16x16x4_f32 v[104:107], v51, v61, v[104:107]
    v_mul_f32 v36, v45, v45
    v_add_f32 v37, v44, v44
    v_fma_f32 v44, v44, v44, -v36
    v_mul_f32 v45, v37, v45
    v_mul_f32 v38, v43, v43
    v_add_f32 v39, v42, v42
    v_fma_f32 v42, v42, v42, -v38
    v_mul_f32 v43, v39, v43
    v_mul_f32 v36, v35, v43
    v_mul_f32 v37, v35, v42
    v_fma_f32 v52, v34, v42, -v36
    v_fma_f32 v53, -v34, v43, -v37
    v_mov_b32 v62, v44
    v_mov_b32 v63, v45
    s_nop 1
    v_mfma_f32_16x16x4_f32 v[108:111], v52, v62, v[108:111]
    v_mfma_f32_16x16x4_f32 v[108:111], v53, v63, v[108:111]
    v_and_b32 v32, s72, v16
    v_and_b32 v33, s72, v20
    v_and_b32 v34, s72, v24
    v_and_b32 v35, s72, v28
    v_mul_f32 v32, 0x3fb8aa3b, v32
    v_exp_f32 v32, v32
    s_nop 0
    v_cvt_pk_bf16_f32 v32, v32, v32
    v_lshlrev_b32 v32, 16, v32
    v_mul_f32 v32, v32, v7
    v_mul_f32 v32, 0xbfb8aa3b, v32
    v_mul_f32 v33, v33, v7
    v_mul_f32 v33, 0x3e22f983, v33
    v_mul_f32 v34, v34, v7
    v_mul_f32 v35, v35, v7
    v_mul_f32 v36, v32, v8
    v_mul_f32 v37, v33, v8
    v_exp_f32 v36, v36
    v_fract_f32 v37, v37
    v_cos_f32 v40, v37
    v_sin_f32 v41, v37
    s_nop 0
    v_mul_f32 v40, v40, v36
    v_mul_f32 v41, v41, v36
    v_mul_f32 v38, v32, v9
    v_mul_f32 v39, v33, v9
    v_exp_f32 v38, v38
    v_fract_f32 v39, v39
    v_cos_f32 v42, v39
    v_sin_f32 v43, v39
    s_nop 0
    v_mul_f32 v42, v42, v38
    v_mul_f32 v43, v43, v38
    v_mul_f32 v36, v32, v10
    v_mul_f32 v37, v33, v10
    v_exp_f32 v36, v36
    v_fract_f32 v37, v37
    v_cos_f32 v44, v37
    v_sin_f32 v45, v37
    s_nop 0
    v_mul_f32 v44, v44, v36
    v_mul_f32 v45, v45, v36
    v_mul_f32 v36, v35, v41
    v_mul_f32 v37, v35, v40
    v_fma_f32 v46, v34, v40, -v36
    v_fma_f32 v47, -v34, v41, -v37
    s_nop 1
    v_mfma_f32_16x16x4_f32 v[96:99], v46, v44, v[96:99]
    v_mfma_f32_16x16x4_f32 v[96:99], v47, v45, v[96:99]
    v_mul_f32 v36, v45, v45
    v_add_f32 v37, v44, v44
    v_fma_f32 v44, v44, v44, -v36
    v_mul_f32 v45, v37, v45
    v_mul_f32 v36, v35, v43
    v_mul_f32 v37, v35, v42
    v_fma_f32 v48, v34, v42, -v36
    v_fma_f32 v49, -v34, v43, -v37
    v_mov_b32 v58, v44
    v_mov_b32 v59, v45
    s_nop 1
    v_mfma_f32_16x16x4_f32 v[100:103], v48, v58, v[100:103]
    v_mfma_f32_16x16x4_f32 v[100:103], v49, v59, v[100:103]
    v_mul_f32 v36, v45, v45
    v_add_f32 v37, v44, v44
    v_fma_f32 v44, v44, v44, -v36
    v_mul_f32 v45, v37, v45
    v_mul_f32 v38, v43, v43
    v_add_f32 v39, v42, v42
    v_fma_f32 v42, v42, v42, -v38
    v_mul_f32 v43, v39, v43
    v_mul_f32 v36, v35, v43
    v_mul_f32 v37, v35, v42
    v_fma_f32 v50, v34, v42, -v36
    v_fma_f32 v51, -v34, v43, -v37
    v_mov_b32 v60, v44
    v_mov_b32 v61, v45
    s_nop 1
    v_mfma_f32_16x16x4_f32 v[104:107], v50, v60, v[104:107]
    v_mfma_f32_16x16x4_f32 v[104:107], v51, v61, v[104:107]
    v_mul_f32 v36, v45, v45
    v_add_f32 v37, v44, v44
    v_fma_f32 v44, v44, v44, -v36
    v_mul_f32 v45, v37, v45
    v_mul_f32 v38, v43, v43
    v_add_f32 v39, v42, v42
    v_fma_f32 v42, v42, v42, -v38
    v_mul_f32 v43, v39, v43
    v_mul_f32 v36, v35, v43
    v_mul_f32 v37, v35, v42
    v_fma_f32 v52, v34, v42, -v36
    v_fma_f32 v53, -v34, v43, -v37
    v_mov_b32 v62, v44
    v_mov_b32 v63, v45
    s_nop 1
    v_mfma_f32_16x16x4_f32 v[108:111], v52, v62, v[108:111]
    v_mfma_f32_16x16x4_f32 v[108:111], v53, v63, v[108:111]
    v_lshlrev_b32 v32, 16, v17
    v_lshlrev_b32 v33, 16, v21
    v_lshlrev_b32 v34, 16, v25
    v_lshlrev_b32 v35, 16, v29
    v_mul_f32 v32, 0x3fb8aa3b, v32
    v_exp_f32 v32, v32
    s_nop 0
    v_cvt_pk_bf16_f32 v32, v32, v32
    v_lshlrev_b32 v32, 16, v32
    v_mul_f32 v32, v32, v7
    v_mul_f32 v32, 0xbfb8aa3b, v32
    v_mul_f32 v33, v33, v7
    v_mul_f32 v33, 0x3e22f983, v33
    v_mul_f32 v34, v34, v7
    v_mul_f32 v35, v35, v7
    v_mul_f32 v36, v32, v8
    v_mul_f32 v37, v33, v8
    v_exp_f32 v36, v36
    v_fract_f32 v37, v37
    v_cos_f32 v40, v37
    v_sin_f32 v41, v37
    s_nop 0
    v_mul_f32 v40, v40, v36
    v_mul_f32 v41, v41, v36
    v_mul_f32 v38, v32, v9
    v_mul_f32 v39, v33, v9
    v_exp_f32 v38, v38
    v_fract_f32 v39, v39
    v_cos_f32 v42, v39
    v_sin_f32 v43, v39
    s_nop 0
    v_mul_f32 v42, v42, v38
    v_mul_f32 v43, v43, v38
    v_mul_f32 v36, v32, v10
    v_mul_f32 v37, v33, v10
    v_exp_f32 v36, v36
    v_fract_f32 v37, v37
    v_cos_f32 v44, v37
    v_sin_f32 v45, v37
    s_nop 0
    v_mul_f32 v44, v44, v36
    v_mul_f32 v45, v45, v36
    v_mul_f32 v36, v35, v41
    v_mul_f32 v37, v35, v40
    v_fma_f32 v46, v34, v40, -v36
    v_fma_f32 v47, -v34, v41, -v37
    s_nop 1
    v_mfma_f32_16x16x4_f32 v[96:99], v46, v44, v[96:99]
    v_mfma_f32_16x16x4_f32 v[96:99], v47, v45, v[96:99]
    v_mul_f32 v36, v45, v45
    v_add_f32 v37, v44, v44
    v_fma_f32 v44, v44, v44, -v36
    v_mul_f32 v45, v37, v45
    v_mul_f32 v36, v35, v43
    v_mul_f32 v37, v35, v42
    v_fma_f32 v48, v34, v42, -v36
    v_fma_f32 v49, -v34, v43, -v37
    v_mov_b32 v58, v44
    v_mov_b32 v59, v45
    s_nop 1
    v_mfma_f32_16x16x4_f32 v[100:103], v48, v58, v[100:103]
    v_mfma_f32_16x16x4_f32 v[100:103], v49, v59, v[100:103]
    v_mul_f32 v36, v45, v45
    v_add_f32 v37, v44, v44
    v_fma_f32 v44, v44, v44, -v36
    v_mul_f32 v45, v37, v45
    v_mul_f32 v38, v43, v43
    v_add_f32 v39, v42, v42
    v_fma_f32 v42, v42, v42, -v38
    v_mul_f32 v43, v39, v43
    v_mul_f32 v36, v35, v43
    v_mul_f32 v37, v35, v42
    v_fma_f32 v50, v34, v42, -v36
    v_fma_f32 v51, -v34, v43, -v37
    v_mov_b32 v60, v44
    v_mov_b32 v61, v45
    s_nop 1
    v_mfma_f32_16x16x4_f32 v[104:107], v50, v60, v[104:107]
    v_mfma_f32_16x16x4_f32 v[104:107], v51, v61, v[104:107]
    v_mul_f32 v36, v45, v45
    v_add_f32 v37, v44, v44
    v_fma_f32 v44, v44, v44, -v36
    v_mul_f32 v45, v37, v45
    v_mul_f32 v38, v43, v43
    v_add_f32 v39, v42, v42
    v_fma_f32 v42, v42, v42, -v38
    v_mul_f32 v43, v39, v43
    v_mul_f32 v36, v35, v43
    v_mul_f32 v37, v35, v42
    v_fma_f32 v52, v34, v42, -v36
    v_fma_f32 v53, -v34, v43, -v37
    v_mov_b32 v62, v44
    v_mov_b32 v63, v45
    s_nop 1
    v_mfma_f32_16x16x4_f32 v[108:111], v52, v62, v[108:111]
    v_mfma_f32_16x16x4_f32 v[108:111], v53, v63, v[108:111]
    v_and_b32 v32, s72, v17
    v_and_b32 v33, s72, v21
    v_and_b32 v34, s72, v25
    v_and_b32 v35, s72, v29
    v_mul_f32 v32, 0x3fb8aa3b, v32
    v_exp_f32 v32, v32
    s_nop 0
    v_cvt_pk_bf16_f32 v32, v32, v32
    v_lshlrev_b32 v32, 16, v32
    v_mul_f32 v32, v32, v7
    v_mul_f32 v32, 0xbfb8aa3b, v32
    v_mul_f32 v33, v33, v7
    v_mul_f32 v33, 0x3e22f983, v33
    v_mul_f32 v34, v34, v7
    v_mul_f32 v35, v35, v7
    v_mul_f32 v36, v32, v8
    v_mul_f32 v37, v33, v8
    v_exp_f32 v36, v36
    v_fract_f32 v37, v37
    v_cos_f32 v40, v37
    v_sin_f32 v41, v37
    s_nop 0
    v_mul_f32 v40, v40, v36
    v_mul_f32 v41, v41, v36
    v_mul_f32 v38, v32, v9
    v_mul_f32 v39, v33, v9
    v_exp_f32 v38, v38
    v_fract_f32 v39, v39
    v_cos_f32 v42, v39
    v_sin_f32 v43, v39
    s_nop 0
    v_mul_f32 v42, v42, v38
    v_mul_f32 v43, v43, v38
    v_mul_f32 v36, v32, v10
    v_mul_f32 v37, v33, v10
    v_exp_f32 v36, v36
    v_fract_f32 v37, v37
    v_cos_f32 v44, v37
    v_sin_f32 v45, v37
    s_nop 0
    v_mul_f32 v44, v44, v36
    v_mul_f32 v45, v45, v36
    v_mul_f32 v36, v35, v41
    v_mul_f32 v37, v35, v40
    v_fma_f32 v46, v34, v40, -v36
    v_fma_f32 v47, -v34, v41, -v37
    s_nop 1
    v_mfma_f32_16x16x4_f32 v[96:99], v46, v44, v[96:99]
    v_mfma_f32_16x16x4_f32 v[96:99], v47, v45, v[96:99]
    v_mul_f32 v36, v45, v45
    v_add_f32 v37, v44, v44
    v_fma_f32 v44, v44, v44, -v36
    v_mul_f32 v45, v37, v45
    v_mul_f32 v36, v35, v43
    v_mul_f32 v37, v35, v42
    v_fma_f32 v48, v34, v42, -v36
    v_fma_f32 v49, -v34, v43, -v37
    v_mov_b32 v58, v44
    v_mov_b32 v59, v45
    s_nop 1
    v_mfma_f32_16x16x4_f32 v[100:103], v48, v58, v[100:103]
    v_mfma_f32_16x16x4_f32 v[100:103], v49, v59, v[100:103]
    v_mul_f32 v36, v45, v45
    v_add_f32 v37, v44, v44
    v_fma_f32 v44, v44, v44, -v36
    v_mul_f32 v45, v37, v45
    v_mul_f32 v38, v43, v43
    v_add_f32 v39, v42, v42
    v_fma_f32 v42, v42, v42, -v38
    v_mul_f32 v43, v39, v43
    v_mul_f32 v36, v35, v43
    v_mul_f32 v37, v35, v42
    v_fma_f32 v50, v34, v42, -v36
    v_fma_f32 v51, -v34, v43, -v37
    v_mov_b32 v60, v44
    v_mov_b32 v61, v45
    s_nop 1
    v_mfma_f32_16x16x4_f32 v[104:107], v50, v60, v[104:107]
    v_mfma_f32_16x16x4_f32 v[104:107], v51, v61, v[104:107]
    v_mul_f32 v36, v45, v45
    v_add_f32 v37, v44, v44
    v_fma_f32 v44, v44, v44, -v36
    v_mul_f32 v45, v37, v45
    v_mul_f32 v38, v43, v43
    v_add_f32 v39, v42, v42
    v_fma_f32 v42, v42, v42, -v38
    v_mul_f32 v43, v39, v43
    v_mul_f32 v36, v35, v43
    v_mul_f32 v37, v35, v42
    v_fma_f32 v52, v34, v42, -v36
    v_fma_f32 v53, -v34, v43, -v37
    v_mov_b32 v62, v44
    v_mov_b32 v63, v45
    s_nop 1
    v_mfma_f32_16x16x4_f32 v[108:111], v52, v62, v[108:111]
    v_mfma_f32_16x16x4_f32 v[108:111], v53, v63, v[108:111]
    s_nop 15
    v_lshlrev_b32 v11, 12, v2
    v_lshl_add_u32 v11, v4, 8, v11
    v_lshl_add_u32 v11, v3, 2, v11
    v_add_u32 v11, 20480, v11
    ds_write_b32 v11, v96 offset:0
    ds_write_b32 v11, v97 offset:64
    ds_write_b32 v11, v98 offset:128
    ds_write_b32 v11, v99 offset:192
    ds_write_b32 v11, v100 offset:1024
    ds_write_b32 v11, v101 offset:1088
    ds_write_b32 v11, v102 offset:1152
    ds_write_b32 v11, v103 offset:1216
    ds_write_b32 v11, v104 offset:2048
    ds_write_b32 v11, v105 offset:2112
    ds_write_b32 v11, v106 offset:2176
    ds_write_b32 v11, v107 offset:2240
    ds_write_b32 v11, v108 offset:3072
    ds_write_b32 v11, v109 offset:3136
    ds_write_b32 v11, v110 offset:3200
    ds_write_b32 v11, v111 offset:3264
    s_waitcnt lgkmcnt(0)
    s_barrier
    s_cmp_lt_u32 s62, 4
    s_cbranch_scc0 G1_END
    v_lshlrev_b32 v11, 2, v0
    v_add_u32 v11, 20480, v11
    ds_read_b32 v16, v11 offset:0
    ds_read_b32 v17, v11 offset:4096
    ds_read_b32 v18, v11 offset:8192
    ds_read_b32 v19, v11 offset:12288
    ds_read_b32 v20, v11 offset:16384
    ds_read_b32 v21, v11 offset:20480
    ds_read_b32 v22, v11 offset:24576
    ds_read_b32 v23, v11 offset:28672
    ds_read_b32 v24, v11 offset:1024
    ds_read_b32 v25, v11 offset:5120
    ds_read_b32 v26, v11 offset:9216
    ds_read_b32 v27, v11 offset:13312
    ds_read_b32 v28, v11 offset:17408
    ds_read_b32 v29, v11 offset:21504
    ds_read_b32 v30, v11 offset:25600
    ds_read_b32 v31, v11 offset:29696
    ds_read_b32 v32, v11 offset:2048
    ds_read_b32 v33, v11 offset:6144
    ds_read_b32 v34, v11 offset:10240
    ds_read_b32 v35, v11 offset:14336
    ds_read_b32 v36, v11 offset:18432
    ds_read_b32 v37, v11 offset:22528
    ds_read_b32 v38, v11 offset:26624
    ds_read_b32 v39, v11 offset:30720
    ds_read_b32 v40, v11 offset:3072
    ds_read_b32 v41, v11 offset:7168
    ds_read_b32 v42, v11 offset:11264
    ds_read_b32 v43, v11 offset:15360
    ds_read_b32 v44, v11 offset:19456
    ds_read_b32 v45, v11 offset:23552
    ds_read_b32 v46, v11 offset:27648
    ds_read_b32 v47, v11 offset:31744
    s_waitcnt lgkmcnt(0)
    v_add_f32 v16, v16, v20
    v_add_f32 v17, v17, v21
    v_add_f32 v18, v18, v22
    v_add_f32 v19, v19, v23
    v_add_f32 v16, v16, v17
    v_add_f32 v18, v18, v19
    v_add_f32 v16, v16, v18
    v_add_f32 v16, v16, v16
    v_add_f32 v24, v24, v28
    v_add_f32 v25, v25, v29
    v_add_f32 v26, v26, v30
    v_add_f32 v27, v27, v31
    v_add_f32 v24, v24, v25
    v_add_f32 v26, v26, v27
    v_add_f32 v24, v24, v26
    v_add_f32 v20, v24, v24
    v_add_f32 v32, v32, v36
    v_add_f32 v33, v33, v37
    v_add_f32 v34, v34, v38
    v_add_f32 v35, v35, v39
    v_add_f32 v32, v32, v33
    v_add_f32 v34, v34, v35
    v_add_f32 v32, v32, v34
    v_add_f32 v24, v32, v32
    v_add_f32 v40, v40, v44
    v_add_f32 v41, v41, v45
    v_add_f32 v42, v42, v46
    v_add_f32 v43, v43, v47
    v_add_f32 v40, v40, v41
    v_add_f32 v42, v42, v43
    v_add_f32 v40, v40, v42
    v_add_f32 v28, v40, v40
    ds_write_b32 v11, v16 offset:32768
    v_cmp_le_u32 vcc, 0x80, v0
    s_and_saveexec_b64 s[48:49], vcc
    ds_write_b32 v11, v20 offset:33280
    ds_write_b32 v11, v24 offset:33792
    ds_write_b32 v11, v28 offset:34304
    s_mov_b64 exec, s[48:49]
    v_cmp_eq_u32 vcc, 0, v0
    s_and_saveexec_b64 s[48:49], vcc
    ds_write_b32 v11, v28 offset:35328
    s_mov_b64 exec, s[48:49]
    s_waitcnt lgkmcnt(0)
    s_barrier
    ds_read_b32 v16, v112 offset:53248
    ds_read_b32 v17, v113 offset:53248
    ds_read_b32 v18, v114 offset:53248
    ds_read_b32 v19, v115 offset:53248
    ds_read_b32 v20, v116 offset:53248
    ds_read_b32 v21, v117 offset:53248
    ds_read_b32 v22, v118 offset:53248
    ds_read_b32 v23, v119 offset:53248
    s_waitcnt lgkmcnt(0)
    v_cvt_pk_bf16_f32 v32, v16, v17
    v_lshlrev_b32 v24, 16, v32
    v_and_b32 v25, s72, v32
    v_sub_f32 v24, v16, v24
    v_sub_f32 v25, v17, v25
    v_cvt_pk_bf16_f32 v36, v24, v25
    v_cvt_pk_bf16_f32 v33, v18, v19
    v_lshlrev_b32 v24, 16, v33
    v_and_b32 v25, s72, v33
    v_sub_f32 v24, v18, v24
    v_sub_f32 v25, v19, v25
    v_cvt_pk_bf16_f32 v37, v24, v25
    v_cvt_pk_bf16_f32 v34, v20, v21
    v_lshlrev_b32 v24, 16, v34
    v_and_b32 v25, s72, v34
    v_sub_f32 v24, v20, v24
    v_sub_f32 v25, v21, v25
    v_cvt_pk_bf16_f32 v38, v24, v25
    v_cvt_pk_bf16_f32 v35, v22, v23
    v_lshlrev_b32 v24, 16, v35
    v_and_b32 v25, s72, v35
    v_sub_f32 v24, v22, v24
    v_sub_f32 v25, v23, v25
    v_cvt_pk_bf16_f32 v39, v24, v25
    v_lshlrev_b32 v11, 4, v0
    ds_write_b128 v11, v[32:35] offset:4160
    ds_write_b128 v11, v[36:39] offset:8768
    v_mov_b32 v40, 0
    v_mov_b32 v41, 0
    v_mov_b32 v42, 0
    v_mov_b32 v43, 0
    v_cmp_gt_u32 vcc, 32, v0
    s_and_saveexec_b64 s[48:49], vcc
    ds_write_b128 v11, v[40:43] offset:8256
    ds_write_b128 v11, v[40:43] offset:12864
    s_mov_b64 exec, s[48:49]
    s_mov_b32 s28, s20
    s_mov_b32 s30, s62
    s_mov_b32 s20, s68
    s_mov_b32 s21, s69
    s_mov_b32 s22, s70
    s_mov_b32 s23, s71
    v_and_b32 v1, 63, v0
    v_lshrrev_b32 v2, 6, v0
    v_and_b32 v3, 15, v1
    v_lshrrev_b32 v4, 4, v1
    v_lshlrev_b32 v16, 4, v1
CONV_L1:
    v_mov_b32 v88, 0
    v_mov_b32 v89, 0
    v_mov_b32 v90, 0
    v_mov_b32 v91, 0
    v_mov_b32 v92, 0
    v_mov_b32 v93, 0
    v_mov_b32 v94, 0
    v_mov_b32 v95, 0
    v_mov_b32 v96, 0
    v_mov_b32 v97, 0
    v_mov_b32 v98, 0
    v_mov_b32 v99, 0
    v_mov_b32 v100, 0
    v_mov_b32 v101, 0
    v_mov_b32 v102, 0
    v_mov_b32 v103, 0
    v_mov_b32 v104, 0
    v_mov_b32 v105, 0
    v_mov_b32 v106, 0
    v_mov_b32 v107, 0
    v_mov_b32 v108, 0
    v_mov_b32 v109, 0
    v_mov_b32 v110, 0
    v_mov_b32 v111, 0
    v_mov_b32 v112, 0
    v_mov_b32 v113, 0
    v_mov_b32 v114, 0
    v_mov_b32 v115, 0
    v_mov_b32 v116, 0
    v_mov_b32 v117, 0
    v_mov_b32 v118, 0
    v_mov_b32 v119, 0
    v_lshlrev_b32 v5, 1, v3
    v_lshl_add_u32 v5, v4, 4, v5
    v_add_u32 v5, 2, v5
    s_lshl_b32 s44, s30, 6
    v_add_u32 v5, s44, v5
    v_lshlrev_b32 v6, 5, v3
    v_sub_u32 v6, 4640, v6
    v_lshl_add_u32 v6, v4, 4, v6
    v_add_u32 v6, s44, v6
    s_waitcnt vmcnt(0) lgkmcnt(0)
    s_barrier
    s_load_dwordx2 s[52:53], s[0:1], 80
    s_lshl_b32 s54, s28, 15
    v_lshlrev_b32 v124, 4, v0
    v_add_u32 v124, s54, v124
    s_waitcnt lgkmcnt(0)
    s_mov_b32 s60, s52
    s_and_b32 s61, s53, 0xffff
    s_mov_b32 s62, 18874368
    s_mov_b32 s63, 0x00020000
    s_mov_b32 s55, 0
    buffer_load_dwordx4 v[120:123], v124, s[60:63], s55 offen
    s_mov_b32 s55, 4096
    buffer_load_dwordx4 v[120:123], v124, s[60:63], s55 offen
    s_mov_b32 s55, 8192
    buffer_load_dwordx4 v[120:123], v124, s[60:63], s55 offen
    s_mov_b32 s55, 12288
    buffer_load_dwordx4 v[120:123], v124, s[60:63], s55 offen
    s_mov_b32 s55, 16384
    buffer_load_dwordx4 v[120:123], v124, s[60:63], s55 offen
    s_mov_b32 s55, 20480
    buffer_load_dwordx4 v[120:123], v124, s[60:63], s55 offen
    s_mov_b32 s55, 24576
    buffer_load_dwordx4 v[120:123], v124, s[60:63], s55 offen
    s_mov_b32 s55, 28672
    buffer_load_dwordx4 v[120:123], v124, s[60:63], s55 offen
    ds_read_b128 v[24:27], v5 offset:0
    ds_read_b128 v[28:31], v5 offset:512
    ds_read_b128 v[32:35], v5 offset:1024
    ds_read_b128 v[36:39], v5 offset:1536
    ds_read_b128 v[40:43], v5 offset:2048
    ds_read_b128 v[44:47], v5 offset:2560
    ds_read_b128 v[48:51], v5 offset:3072
    ds_read_b128 v[52:55], v5 offset:3584
    ds_read_b128 v[56:59], v6 offset:3584
    ds_read_b128 v[60:63], v6 offset:3072
    ds_read_b128 v[64:67], v6 offset:2560
    ds_read_b128 v[68:71], v6 offset:2048
    ds_read_b128 v[72:75], v6 offset:1536
    ds_read_b128 v[76:79], v6 offset:1024
    ds_read_b128 v[80:83], v6 offset:512
    ds_read_b128 v[84:87], v6 offset:0
    s_waitcnt lgkmcnt(0)
    v_mfma_f32_16x16x32_bf16 v[116:119], v[24:27], v[84:87], v[116:119]
    v_mfma_f32_16x16x32_bf16 v[116:119], v[28:31], v[80:83], v[116:119]
    v_mfma_f32_16x16x32_bf16 v[116:119], v[32:35], v[76:79], v[116:119]
    v_mfma_f32_16x16x32_bf16 v[116:119], v[36:39], v[72:75], v[116:119]
    v_mfma_f32_16x16x32_bf16 v[116:119], v[40:43], v[68:71], v[116:119]
    v_mfma_f32_16x16x32_bf16 v[116:119], v[44:47], v[64:67], v[116:119]
    v_mfma_f32_16x16x32_bf16 v[116:119], v[48:51], v[60:63], v[116:119]
    v_mfma_f32_16x16x32_bf16 v[116:119], v[52:55], v[56:59], v[116:119]
    v_mfma_f32_16x16x32_bf16 v[112:115], v[24:27], v[80:83], v[112:115]
    v_mfma_f32_16x16x32_bf16 v[112:115], v[28:31], v[76:79], v[112:115]
    v_mfma_f32_16x16x32_bf16 v[112:115], v[32:35], v[72:75], v[112:115]
    v_mfma_f32_16x16x32_bf16 v[112:115], v[36:39], v[68:71], v[112:115]
    v_mfma_f32_16x16x32_bf16 v[112:115], v[40:43], v[64:67], v[112:115]
    v_mfma_f32_16x16x32_bf16 v[112:115], v[44:47], v[60:63], v[112:115]
    v_mfma_f32_16x16x32_bf16 v[112:115], v[48:51], v[56:59], v[112:115]
    v_mfma_f32_16x16x32_bf16 v[108:111], v[24:27], v[76:79], v[108:111]
    v_mfma_f32_16x16x32_bf16 v[108:111], v[28:31], v[72:75], v[108:111]
    v_mfma_f32_16x16x32_bf16 v[108:111], v[32:35], v[68:71], v[108:111]
    v_mfma_f32_16x16x32_bf16 v[108:111], v[36:39], v[64:67], v[108:111]
    v_mfma_f32_16x16x32_bf16 v[108:111], v[40:43], v[60:63], v[108:111]
    v_mfma_f32_16x16x32_bf16 v[108:111], v[44:47], v[56:59], v[108:111]
    v_mfma_f32_16x16x32_bf16 v[104:107], v[24:27], v[72:75], v[104:107]
    v_mfma_f32_16x16x32_bf16 v[104:107], v[28:31], v[68:71], v[104:107]
    v_mfma_f32_16x16x32_bf16 v[104:107], v[32:35], v[64:67], v[104:107]
    v_mfma_f32_16x16x32_bf16 v[104:107], v[36:39], v[60:63], v[104:107]
    v_mfma_f32_16x16x32_bf16 v[104:107], v[40:43], v[56:59], v[104:107]
    v_mfma_f32_16x16x32_bf16 v[100:103], v[24:27], v[68:71], v[100:103]
    v_mfma_f32_16x16x32_bf16 v[100:103], v[28:31], v[64:67], v[100:103]
    v_mfma_f32_16x16x32_bf16 v[100:103], v[32:35], v[60:63], v[100:103]
    v_mfma_f32_16x16x32_bf16 v[100:103], v[36:39], v[56:59], v[100:103]
    v_mfma_f32_16x16x32_bf16 v[96:99], v[24:27], v[64:67], v[96:99]
    v_mfma_f32_16x16x32_bf16 v[96:99], v[28:31], v[60:63], v[96:99]
    v_mfma_f32_16x16x32_bf16 v[96:99], v[32:35], v[56:59], v[96:99]
    v_mfma_f32_16x16x32_bf16 v[92:95], v[24:27], v[60:63], v[92:95]
    v_mfma_f32_16x16x32_bf16 v[92:95], v[28:31], v[56:59], v[92:95]
    v_mfma_f32_16x16x32_bf16 v[88:91], v[24:27], v[56:59], v[88:91]
    ds_read_b128 v[56:59], v6 offset:8192
    ds_read_b128 v[60:63], v6 offset:7680
    ds_read_b128 v[64:67], v6 offset:7168
    ds_read_b128 v[68:71], v6 offset:6656
    ds_read_b128 v[72:75], v6 offset:6144
    ds_read_b128 v[76:79], v6 offset:5632
    ds_read_b128 v[80:83], v6 offset:5120
    ds_read_b128 v[84:87], v6 offset:4608
    s_waitcnt lgkmcnt(0)
    v_mfma_f32_16x16x32_bf16 v[116:119], v[24:27], v[84:87], v[116:119]
    v_mfma_f32_16x16x32_bf16 v[116:119], v[28:31], v[80:83], v[116:119]
    v_mfma_f32_16x16x32_bf16 v[116:119], v[32:35], v[76:79], v[116:119]
    v_mfma_f32_16x16x32_bf16 v[116:119], v[36:39], v[72:75], v[116:119]
    v_mfma_f32_16x16x32_bf16 v[116:119], v[40:43], v[68:71], v[116:119]
    v_mfma_f32_16x16x32_bf16 v[116:119], v[44:47], v[64:67], v[116:119]
    v_mfma_f32_16x16x32_bf16 v[116:119], v[48:51], v[60:63], v[116:119]
    v_mfma_f32_16x16x32_bf16 v[116:119], v[52:55], v[56:59], v[116:119]
    v_mfma_f32_16x16x32_bf16 v[112:115], v[24:27], v[80:83], v[112:115]
    v_mfma_f32_16x16x32_bf16 v[112:115], v[28:31], v[76:79], v[112:115]
    v_mfma_f32_16x16x32_bf16 v[112:115], v[32:35], v[72:75], v[112:115]
    v_mfma_f32_16x16x32_bf16 v[112:115], v[36:39], v[68:71], v[112:115]
    v_mfma_f32_16x16x32_bf16 v[112:115], v[40:43], v[64:67], v[112:115]
    v_mfma_f32_16x16x32_bf16 v[112:115], v[44:47], v[60:63], v[112:115]
    v_mfma_f32_16x16x32_bf16 v[112:115], v[48:51], v[56:59], v[112:115]
    v_mfma_f32_16x16x32_bf16 v[108:111], v[24:27], v[76:79], v[108:111]
    v_mfma_f32_16x16x32_bf16 v[108:111], v[28:31], v[72:75], v[108:111]
    v_mfma_f32_16x16x32_bf16 v[108:111], v[32:35], v[68:71], v[108:111]
    v_mfma_f32_16x16x32_bf16 v[108:111], v[36:39], v[64:67], v[108:111]
    v_mfma_f32_16x16x32_bf16 v[108:111], v[40:43], v[60:63], v[108:111]
    v_mfma_f32_16x16x32_bf16 v[108:111], v[44:47], v[56:59], v[108:111]
    v_mfma_f32_16x16x32_bf16 v[104:107], v[24:27], v[72:75], v[104:107]
    v_mfma_f32_16x16x32_bf16 v[104:107], v[28:31], v[68:71], v[104:107]
    v_mfma_f32_16x16x32_bf16 v[104:107], v[32:35], v[64:67], v[104:107]
    v_mfma_f32_16x16x32_bf16 v[104:107], v[36:39], v[60:63], v[104:107]
    v_mfma_f32_16x16x32_bf16 v[104:107], v[40:43], v[56:59], v[104:107]
    v_mfma_f32_16x16x32_bf16 v[100:103], v[24:27], v[68:71], v[100:103]
    v_mfma_f32_16x16x32_bf16 v[100:103], v[28:31], v[64:67], v[100:103]
    v_mfma_f32_16x16x32_bf16 v[100:103], v[32:35], v[60:63], v[100:103]
    v_mfma_f32_16x16x32_bf16 v[100:103], v[36:39], v[56:59], v[100:103]
    v_mfma_f32_16x16x32_bf16 v[96:99], v[24:27], v[64:67], v[96:99]
    v_mfma_f32_16x16x32_bf16 v[96:99], v[28:31], v[60:63], v[96:99]
    v_mfma_f32_16x16x32_bf16 v[96:99], v[32:35], v[56:59], v[96:99]
    v_mfma_f32_16x16x32_bf16 v[92:95], v[24:27], v[60:63], v[92:95]
    v_mfma_f32_16x16x32_bf16 v[92:95], v[28:31], v[56:59], v[92:95]
    v_mfma_f32_16x16x32_bf16 v[88:91], v[24:27], v[56:59], v[88:91]
    ds_read_b128 v[24:27], v5 offset:256
    ds_read_b128 v[28:31], v5 offset:768
    ds_read_b128 v[32:35], v5 offset:1280
    ds_read_b128 v[36:39], v5 offset:1792
    ds_read_b128 v[40:43], v5 offset:2304
    ds_read_b128 v[44:47], v5 offset:2816
    ds_read_b128 v[48:51], v5 offset:3328
    ds_read_b128 v[52:55], v5 offset:3840
    ds_read_b128 v[56:59], v6 offset:3840
    ds_read_b128 v[60:63], v6 offset:3328
    ds_read_b128 v[64:67], v6 offset:2816
    ds_read_b128 v[68:71], v6 offset:2304
    ds_read_b128 v[72:75], v6 offset:1792
    ds_read_b128 v[76:79], v6 offset:1280
    ds_read_b128 v[80:83], v6 offset:768
    ds_read_b128 v[84:87], v6 offset:256
    s_waitcnt lgkmcnt(0)
    v_mfma_f32_16x16x32_bf16 v[116:119], v[24:27], v[84:87], v[116:119]
    v_mfma_f32_16x16x32_bf16 v[116:119], v[28:31], v[80:83], v[116:119]
    v_mfma_f32_16x16x32_bf16 v[116:119], v[32:35], v[76:79], v[116:119]
    v_mfma_f32_16x16x32_bf16 v[116:119], v[36:39], v[72:75], v[116:119]
    v_mfma_f32_16x16x32_bf16 v[116:119], v[40:43], v[68:71], v[116:119]
    v_mfma_f32_16x16x32_bf16 v[116:119], v[44:47], v[64:67], v[116:119]
    v_mfma_f32_16x16x32_bf16 v[116:119], v[48:51], v[60:63], v[116:119]
    v_mfma_f32_16x16x32_bf16 v[116:119], v[52:55], v[56:59], v[116:119]
    v_mfma_f32_16x16x32_bf16 v[112:115], v[24:27], v[80:83], v[112:115]
    v_mfma_f32_16x16x32_bf16 v[112:115], v[28:31], v[76:79], v[112:115]
    v_mfma_f32_16x16x32_bf16 v[112:115], v[32:35], v[72:75], v[112:115]
    v_mfma_f32_16x16x32_bf16 v[112:115], v[36:39], v[68:71], v[112:115]
    v_mfma_f32_16x16x32_bf16 v[112:115], v[40:43], v[64:67], v[112:115]
    v_mfma_f32_16x16x32_bf16 v[112:115], v[44:47], v[60:63], v[112:115]
    v_mfma_f32_16x16x32_bf16 v[112:115], v[48:51], v[56:59], v[112:115]
    v_mfma_f32_16x16x32_bf16 v[108:111], v[24:27], v[76:79], v[108:111]
    v_mfma_f32_16x16x32_bf16 v[108:111], v[28:31], v[72:75], v[108:111]
    v_mfma_f32_16x16x32_bf16 v[108:111], v[32:35], v[68:71], v[108:111]
    v_mfma_f32_16x16x32_bf16 v[108:111], v[36:39], v[64:67], v[108:111]
    v_mfma_f32_16x16x32_bf16 v[108:111], v[40:43], v[60:63], v[108:111]
    v_mfma_f32_16x16x32_bf16 v[108:111], v[44:47], v[56:59], v[108:111]
    v_mfma_f32_16x16x32_bf16 v[104:107], v[24:27], v[72:75], v[104:107]
    v_mfma_f32_16x16x32_bf16 v[104:107], v[28:31], v[68:71], v[104:107]
    v_mfma_f32_16x16x32_bf16 v[104:107], v[32:35], v[64:67], v[104:107]
    v_mfma_f32_16x16x32_bf16 v[104:107], v[36:39], v[60:63], v[104:107]
    v_mfma_f32_16x16x32_bf16 v[104:107], v[40:43], v[56:59], v[104:107]
    v_mfma_f32_16x16x32_bf16 v[100:103], v[24:27], v[68:71], v[100:103]
    v_mfma_f32_16x16x32_bf16 v[100:103], v[28:31], v[64:67], v[100:103]
    v_mfma_f32_16x16x32_bf16 v[100:103], v[32:35], v[60:63], v[100:103]
    v_mfma_f32_16x16x32_bf16 v[100:103], v[36:39], v[56:59], v[100:103]
    v_mfma_f32_16x16x32_bf16 v[96:99], v[24:27], v[64:67], v[96:99]
    v_mfma_f32_16x16x32_bf16 v[96:99], v[28:31], v[60:63], v[96:99]
    v_mfma_f32_16x16x32_bf16 v[96:99], v[32:35], v[56:59], v[96:99]
    v_mfma_f32_16x16x32_bf16 v[92:95], v[24:27], v[60:63], v[92:95]
    v_mfma_f32_16x16x32_bf16 v[92:95], v[28:31], v[56:59], v[92:95]
    v_mfma_f32_16x16x32_bf16 v[88:91], v[24:27], v[56:59], v[88:91]
    ds_read_b128 v[56:59], v6 offset:8448
    ds_read_b128 v[60:63], v6 offset:7936
    ds_read_b128 v[64:67], v6 offset:7424
    ds_read_b128 v[68:71], v6 offset:6912
    ds_read_b128 v[72:75], v6 offset:6400
    ds_read_b128 v[76:79], v6 offset:5888
    ds_read_b128 v[80:83], v6 offset:5376
    ds_read_b128 v[84:87], v6 offset:4864
    s_waitcnt lgkmcnt(0)
    v_mfma_f32_16x16x32_bf16 v[116:119], v[24:27], v[84:87], v[116:119]
    v_mfma_f32_16x16x32_bf16 v[116:119], v[28:31], v[80:83], v[116:119]
    v_mfma_f32_16x16x32_bf16 v[116:119], v[32:35], v[76:79], v[116:119]
    v_mfma_f32_16x16x32_bf16 v[116:119], v[36:39], v[72:75], v[116:119]
    v_mfma_f32_16x16x32_bf16 v[116:119], v[40:43], v[68:71], v[116:119]
    v_mfma_f32_16x16x32_bf16 v[116:119], v[44:47], v[64:67], v[116:119]
    v_mfma_f32_16x16x32_bf16 v[116:119], v[48:51], v[60:63], v[116:119]
    v_mfma_f32_16x16x32_bf16 v[116:119], v[52:55], v[56:59], v[116:119]
    v_mfma_f32_16x16x32_bf16 v[112:115], v[24:27], v[80:83], v[112:115]
    v_mfma_f32_16x16x32_bf16 v[112:115], v[28:31], v[76:79], v[112:115]
    v_mfma_f32_16x16x32_bf16 v[112:115], v[32:35], v[72:75], v[112:115]
    v_mfma_f32_16x16x32_bf16 v[112:115], v[36:39], v[68:71], v[112:115]
    v_mfma_f32_16x16x32_bf16 v[112:115], v[40:43], v[64:67], v[112:115]
    v_mfma_f32_16x16x32_bf16 v[112:115], v[44:47], v[60:63], v[112:115]
    v_mfma_f32_16x16x32_bf16 v[112:115], v[48:51], v[56:59], v[112:115]
    v_mfma_f32_16x16x32_bf16 v[108:111], v[24:27], v[76:79], v[108:111]
    v_mfma_f32_16x16x32_bf16 v[108:111], v[28:31], v[72:75], v[108:111]
    v_mfma_f32_16x16x32_bf16 v[108:111], v[32:35], v[68:71], v[108:111]
    v_mfma_f32_16x16x32_bf16 v[108:111], v[36:39], v[64:67], v[108:111]
    v_mfma_f32_16x16x32_bf16 v[108:111], v[40:43], v[60:63], v[108:111]
    v_mfma_f32_16x16x32_bf16 v[108:111], v[44:47], v[56:59], v[108:111]
    v_mfma_f32_16x16x32_bf16 v[104:107], v[24:27], v[72:75], v[104:107]
    v_mfma_f32_16x16x32_bf16 v[104:107], v[28:31], v[68:71], v[104:107]
    v_mfma_f32_16x16x32_bf16 v[104:107], v[32:35], v[64:67], v[104:107]
    v_mfma_f32_16x16x32_bf16 v[104:107], v[36:39], v[60:63], v[104:107]
    v_mfma_f32_16x16x32_bf16 v[104:107], v[40:43], v[56:59], v[104:107]
    v_mfma_f32_16x16x32_bf16 v[100:103], v[24:27], v[68:71], v[100:103]
    v_mfma_f32_16x16x32_bf16 v[100:103], v[28:31], v[64:67], v[100:103]
    v_mfma_f32_16x16x32_bf16 v[100:103], v[32:35], v[60:63], v[100:103]
    v_mfma_f32_16x16x32_bf16 v[100:103], v[36:39], v[56:59], v[100:103]
    v_mfma_f32_16x16x32_bf16 v[96:99], v[24:27], v[64:67], v[96:99]
    v_mfma_f32_16x16x32_bf16 v[96:99], v[28:31], v[60:63], v[96:99]
    v_mfma_f32_16x16x32_bf16 v[96:99], v[32:35], v[56:59], v[96:99]
    v_mfma_f32_16x16x32_bf16 v[92:95], v[24:27], v[60:63], v[92:95]
    v_mfma_f32_16x16x32_bf16 v[92:95], v[28:31], v[56:59], v[92:95]
    v_mfma_f32_16x16x32_bf16 v[88:91], v[24:27], v[56:59], v[88:91]
    s_nop 15
    s_lshl_b32 s44, s30, 13
    s_add_u32 s44, s44, 16384
    v_add_u32 v7, s44, v16
    ds_write_b128 v7, v[88:91] offset:0
    ds_write_b128 v7, v[92:95] offset:1024
    ds_write_b128 v7, v[96:99] offset:2048
    ds_write_b128 v7, v[100:103] offset:3072
    ds_write_b128 v7, v[104:107] offset:4096
    ds_write_b128 v7, v[108:111] offset:5120
    ds_write_b128 v7, v[112:115] offset:6144
    ds_write_b128 v7, v[116:119] offset:7168
    s_waitcnt lgkmcnt(0)
    s_barrier
    s_lshl_b32 s44, s30, 11
    s_add_u32 s44, s44, 16384
    v_add_u32 v7, s44, v16
    ds_read_b128 v[24:27], v7 offset:0
    ds_read_b128 v[28:31], v7 offset:8192
    ds_read_b128 v[32:35], v7 offset:16384
    ds_read_b128 v[36:39], v7 offset:24576
    ds_read_b128 v[40:43], v7 offset:1024
    ds_read_b128 v[44:47], v7 offset:9216
    ds_read_b128 v[48:51], v7 offset:17408
    ds_read_b128 v[52:55], v7 offset:25600
    s_waitcnt lgkmcnt(0)
    v_lshlrev_b32 v8, 5, v3
    v_lshl_add_u32 v8, v4, 3, v8
    s_lshl_b32 s44, s28, 12
    s_lshl_b32 s45, s30, 10
    s_add_u32 s44, s44, s45
    v_add_u32 v8, s44, v8
    v_add_f32 v24, v24, v28
    v_add_f32 v32, v32, v36
    v_add_f32 v24, v24, v32
    v_add_f32 v25, v25, v29
    v_add_f32 v33, v33, v37
    v_add_f32 v25, v25, v33
    v_add_f32 v26, v26, v30
    v_add_f32 v34, v34, v38
    v_add_f32 v26, v26, v34
    v_add_f32 v27, v27, v31
    v_add_f32 v35, v35, v39
    v_add_f32 v27, v27, v35
    v_cvt_pk_bf16_f32 v60, v24, v25
    v_cvt_pk_bf16_f32 v61, v26, v27
    buffer_store_dwordx2 v[60:61], v8, s[20:23], 0 offen offset:0
    v_add_f32 v40, v40, v44
    v_add_f32 v48, v48, v52
    v_add_f32 v40, v40, v48
    v_add_f32 v41, v41, v45
    v_add_f32 v49, v49, v53
    v_add_f32 v41, v41, v49
    v_add_f32 v42, v42, v46
    v_add_f32 v50, v50, v54
    v_add_f32 v42, v42, v50
    v_add_f32 v43, v43, v47
    v_add_f32 v51, v51, v55
    v_add_f32 v43, v43, v51
    v_cvt_pk_bf16_f32 v62, v40, v41
    v_cvt_pk_bf16_f32 v63, v42, v43
    buffer_store_dwordx2 v[62:63], v8, s[20:23], 0 offen offset:512
    s_waitcnt vmcnt(0)
    s_endpgm
.globl gated_mix__ssm_conv_s4d__mixer_token_mlp__prompt_kernel
.p2align 8
.type gated_mix__ssm_conv_s4d__mixer_token_mlp__prompt_kernel,@function
gated_mix__ssm_conv_s4d__mixer_token_mlp__prompt_kernel:
    s_cmp_lt_u32 s2, 256
    s_cbranch_scc1 F_START
    s_endpgm
F_START:
    s_load_dwordx2 s[4:5], s[0:1], 80
    s_load_dwordx2 s[6:7], s[0:1], 120
    s_load_dwordx2 s[8:9], s[0:1], 48
    s_load_dwordx2 s[10:11], s[0:1], 88
    s_load_dwordx2 s[40:41], s[0:1], 104
    s_load_dwordx2 s[42:43], s[0:1], 0
    s_and_b32 s60, s2, 7
    s_lshr_b32 s61, s2, 3
    s_and_b32 s50, s61, 7
    s_lshl_b32 s51, s60, 2
    s_lshr_b32 s62, s61, 3
    s_add_u32 s51, s51, s62
    s_mul_i32 s52, s50, 9
    s_lshr_b32 s52, s52, 1
    v_and_b32 v1, 63, v0
    v_lshrrev_b32 v2, 6, v0
    s_nop 0
    v_readfirstlane_b32 s53, v2
    v_lshrrev_b32 v3, 4, v1
    v_bfe_u32 v4, v1, 2, 2
    v_and_b32 v5, 3, v1
    v_and_b32 v15, 15, v1
    v_lshlrev_b32 v16, 4, v1
    v_lshrrev_b32 v6, 3, v1
    v_and_b32 v7, 7, v1
    v_lshlrev_b32 v8, 1, v3
    v_xor_b32 v8, v8, v7
    v_lshlrev_b32 v8, 4, v8
    v_lshl_add_u32 v14, v6, 12, v8
    v_lshlrev_b32 v9, 4, v7
    v_lshl_add_u32 v17, v6, 12, v9
    s_lshl_b32 s60, s53, 12
    v_lshl_add_u32 v6, v3, 2, v4
    v_lshlrev_b32 v6, 7, v6
    v_add_u32 v6, s60, v6
    v_and_b32 v7, 1, v5
    v_lshl_add_u32 v6, v7, 3, v6
    v_lshrrev_b32 v7, 1, v4
    v_lshl_add_u32 v7, v3, 1, v7
    v_and_b32 v7, 3, v7
    v_lshlrev_b32 v7, 1, v7
    v_lshrrev_b32 v8, 1, v5
    v_xor_b32 v9, 0, v7
    v_or_b32 v9, v9, v8
    v_lshl_add_u32 v10, v9, 4, v6
    v_xor_b32 v9, 2, v7
    v_or_b32 v9, v9, v8
    v_lshl_add_u32 v11, v9, 4, v6
    v_xor_b32 v9, 4, v7
    v_or_b32 v9, v9, v8
    v_lshl_add_u32 v12, v9, 4, v6
    v_xor_b32 v9, 6, v7
    v_or_b32 v9, v9, v8
    v_lshl_add_u32 v13, v9, 4, v6
    s_waitcnt lgkmcnt(0)
    s_mov_b32 s12, s4
    s_and_b32 s13, s5, 0xffff
    s_mov_b32 s14, 18874368
    s_mov_b32 s15, 0x00020000
    s_add_u32 s16, s6, 12451840
    s_addc_u32 s17, s7, 0
    s_and_b32 s17, s17, 0xffff
    s_mov_b32 s18, 5308416
    s_mov_b32 s19, 0x00020000
    s_add_u32 s20, s6, 4718592
    s_addc_u32 s21, s7, 0
    s_and_b32 s21, s21, 0xffff
    s_mov_b32 s22, 2359296
    s_mov_b32 s23, 0x00020000
    s_add_u32 s24, s6, 7077888
    s_addc_u32 s25, s7, 0
    s_and_b32 s25, s25, 0xffff
    s_mov_b32 s26, 8192
    s_mov_b32 s27, 0x00020000
    s_mov_b32 s28, s8
    s_and_b32 s29, s9, 0xffff
    s_mov_b32 s30, 1152
    s_mov_b32 s31, 0x00020000
    s_mov_b32 s32, s10
    s_and_b32 s33, s11, 0xffff
    s_mov_b32 s34, 4096
    s_mov_b32 s35, 0x00020000
    s_mov_b32 s36, s40
    s_and_b32 s37, s41, 0xffff
    s_mov_b32 s38, 2359296
    s_mov_b32 s39, 0x00020000
    s_mov_b32 s44, s42
    s_and_b32 s45, s43, 0xffff
    s_mov_b32 s46, 2359296
    s_mov_b32 s47, 0x00020000
    s_lshl_b32 s61, s52, 16
    s_lshl_b32 s62, s51, 7
    s_add_u32 s61, s61, s62
    s_lshl_b32 s62, s53, 15
    s_add_u32 s61, s61, s62
    s_lshl_b32 s62, s53, 10
    s_add_u32 m0, s62, 81920
    s_nop 0
    buffer_load_dwordx4 v17, s[20:23], s61 offen lds
    s_cmp_lt_u32 s53, 2
    s_cbranch_scc0 F_Y1
    s_add_u32 m0, s62, 90112
    s_add_u32 s61, s61, 262144
    buffer_load_dwordx4 v17, s[20:23], s61 offen lds
F_Y1:
    s_mul_i32 s54, s53, 576
    s_lshl_b32 s54, s54, 12
    s_lshl_b32 s61, s51, 7
    s_add_u32 s54, s54, s61
    s_mul_i32 s55, s52, 144
    s_mul_i32 s61, s53, 18
    s_add_u32 s55, s55, s61
    s_lshl_b32 s55, s55, 10
    s_add_u32 s56, s55, 147456
    s_add_u32 s57, s55, 294912
    s_add_u32 s58, s55, 442368
    s_add_u32 s59, s55, 589824
    v_add_u32 v17, s60, v16
    s_add_u32 s61, s54, 0
    buffer_load_dwordx4 v[180:183], v14, s[12:15], s61 offen
    s_add_u32 s61, s54, 32768
    buffer_load_dwordx4 v[184:187], v14, s[12:15], s61 offen
    s_add_u32 s61, s54, 65536
    buffer_load_dwordx4 v[188:191], v14, s[12:15], s61 offen
    s_add_u32 s61, s54, 98304
    buffer_load_dwordx4 v[192:195], v14, s[12:15], s61 offen
    s_add_u32 s54, s54, 131072
    buffer_load_dwordx4 v[40:43], v16, s[16:19], s55 offen
    s_add_u32 s55, s55, 1024
    buffer_load_dwordx4 v[44:47], v16, s[16:19], s56 offen
    s_add_u32 s56, s56, 1024
    buffer_load_dwordx4 v[48:51], v16, s[16:19], s57 offen
    s_add_u32 s57, s57, 1024
    buffer_load_dwordx4 v[52:55], v16, s[16:19], s58 offen
    s_add_u32 s58, s58, 1024
    buffer_load_dwordx4 v[56:59], v16, s[16:19], s59 offen
    s_add_u32 s59, s59, 1024
    s_add_u32 s61, s54, 0
    buffer_load_dwordx4 v[196:199], v14, s[12:15], s61 offen
    s_add_u32 s61, s54, 32768
    buffer_load_dwordx4 v[200:203], v14, s[12:15], s61 offen
    s_add_u32 s61, s54, 65536
    buffer_load_dwordx4 v[204:207], v14, s[12:15], s61 offen
    s_add_u32 s61, s54, 98304
    buffer_load_dwordx4 v[208:211], v14, s[12:15], s61 offen
    s_add_u32 s54, s54, 131072
    buffer_load_dwordx4 v[60:63], v16, s[16:19], s55 offen
    s_add_u32 s55, s55, 1024
    buffer_load_dwordx4 v[64:67], v16, s[16:19], s56 offen
    s_add_u32 s56, s56, 1024
    buffer_load_dwordx4 v[68:71], v16, s[16:19], s57 offen
    s_add_u32 s57, s57, 1024
    buffer_load_dwordx4 v[72:75], v16, s[16:19], s58 offen
    s_add_u32 s58, s58, 1024
    buffer_load_dwordx4 v[76:79], v16, s[16:19], s59 offen
    s_add_u32 s59, s59, 1024
    s_add_u32 s61, s54, 0
    buffer_load_dwordx4 v[212:215], v14, s[12:15], s61 offen
    s_add_u32 s61, s54, 32768
    buffer_load_dwordx4 v[216:219], v14, s[12:15], s61 offen
    s_add_u32 s61, s54, 65536
    buffer_load_dwordx4 v[220:223], v14, s[12:15], s61 offen
    s_add_u32 s61, s54, 98304
    buffer_load_dwordx4 v[224:227], v14, s[12:15], s61 offen
    s_add_u32 s54, s54, 131072
    buffer_load_dwordx4 v[80:83], v16, s[16:19], s55 offen
    s_add_u32 s55, s55, 1024
    buffer_load_dwordx4 v[84:87], v16, s[16:19], s56 offen
    s_add_u32 s56, s56, 1024
    buffer_load_dwordx4 v[88:91], v16, s[16:19], s57 offen
    s_add_u32 s57, s57, 1024
    buffer_load_dwordx4 v[92:95], v16, s[16:19], s58 offen
    s_add_u32 s58, s58, 1024
    buffer_load_dwordx4 v[96:99], v16, s[16:19], s59 offen
    s_add_u32 s59, s59, 1024
    v_mov_b32 v100, 0
    v_mov_b32 v101, 0
    v_mov_b32 v102, 0
    v_mov_b32 v103, 0
    v_mov_b32 v104, 0
    v_mov_b32 v105, 0
    v_mov_b32 v106, 0
    v_mov_b32 v107, 0
    v_mov_b32 v108, 0
    v_mov_b32 v109, 0
    v_mov_b32 v110, 0
    v_mov_b32 v111, 0
    v_mov_b32 v112, 0
    v_mov_b32 v113, 0
    v_mov_b32 v114, 0
    v_mov_b32 v115, 0
    v_mov_b32 v116, 0
    v_mov_b32 v117, 0
    v_mov_b32 v118, 0
    v_mov_b32 v119, 0
    v_mov_b32 v120, 0
    v_mov_b32 v121, 0
    v_mov_b32 v122, 0
    v_mov_b32 v123, 0
    v_mov_b32 v124, 0
    v_mov_b32 v125, 0
    v_mov_b32 v126, 0
    v_mov_b32 v127, 0
    v_mov_b32 v128, 0
    v_mov_b32 v129, 0
    v_mov_b32 v130, 0
    v_mov_b32 v131, 0
    v_mov_b32 v132, 0
    v_mov_b32 v133, 0
    v_mov_b32 v134, 0
    v_mov_b32 v135, 0
    v_mov_b32 v136, 0
    v_mov_b32 v137, 0
    v_mov_b32 v138, 0
    v_mov_b32 v139, 0
    v_mov_b32 v140, 0
    v_mov_b32 v141, 0
    v_mov_b32 v142, 0
    v_mov_b32 v143, 0
    v_mov_b32 v144, 0
    v_mov_b32 v145, 0
    v_mov_b32 v146, 0
    v_mov_b32 v147, 0
    v_mov_b32 v148, 0
    v_mov_b32 v149, 0
    v_mov_b32 v150, 0
    v_mov_b32 v151, 0
    v_mov_b32 v152, 0
    v_mov_b32 v153, 0
    v_mov_b32 v154, 0
    v_mov_b32 v155, 0
    v_mov_b32 v156, 0
    v_mov_b32 v157, 0
    v_mov_b32 v158, 0
    v_mov_b32 v159, 0
    v_mov_b32 v160, 0
    v_mov_b32 v161, 0
    v_mov_b32 v162, 0
    v_mov_b32 v163, 0
    v_mov_b32 v164, 0
    v_mov_b32 v165, 0
    v_mov_b32 v166, 0
    v_mov_b32 v167, 0
    v_mov_b32 v168, 0
    v_mov_b32 v169, 0
    v_mov_b32 v170, 0
    v_mov_b32 v171, 0
    v_mov_b32 v172, 0
    v_mov_b32 v173, 0
    v_mov_b32 v174, 0
    v_mov_b32 v175, 0
    v_mov_b32 v176, 0
    v_mov_b32 v177, 0
    v_mov_b32 v178, 0
    v_mov_b32 v179, 0
    s_waitcnt vmcnt(18)
    ds_write_b128 v17, v[180:183] offset:0
    ds_write_b128 v17, v[184:187] offset:1024
    ds_write_b128 v17, v[188:191] offset:2048
    ds_write_b128 v17, v[192:195] offset:3072
    s_waitcnt lgkmcnt(0)
    ds_read_b64_tr_b16 v[20:21], v10
    ds_read_b64_tr_b16 v[22:23], v10 offset:2048
    ds_read_b64_tr_b16 v[24:25], v11
    ds_read_b64_tr_b16 v[26:27], v11 offset:2048
    ds_read_b64_tr_b16 v[28:29], v12
    ds_read_b64_tr_b16 v[30:31], v12 offset:2048
    ds_read_b64_tr_b16 v[32:33], v13
    ds_read_b64_tr_b16 v[34:35], v13 offset:2048
    s_waitcnt lgkmcnt(0)
    v_mfma_f32_16x16x32_bf16 v[100:103], v[40:43], v[20:23], v[100:103]
    s_add_u32 s61, s54, 0
    buffer_load_dwordx4 v[180:183], v14, s[12:15], s61 offen
    v_mfma_f32_16x16x32_bf16 v[104:107], v[40:43], v[24:27], v[104:107]
    s_add_u32 s61, s54, 32768
    buffer_load_dwordx4 v[184:187], v14, s[12:15], s61 offen
    v_mfma_f32_16x16x32_bf16 v[108:111], v[40:43], v[28:31], v[108:111]
    s_add_u32 s61, s54, 65536
    buffer_load_dwordx4 v[188:191], v14, s[12:15], s61 offen
    v_mfma_f32_16x16x32_bf16 v[112:115], v[40:43], v[32:35], v[112:115]
    s_add_u32 s61, s54, 98304
    buffer_load_dwordx4 v[192:195], v14, s[12:15], s61 offen
    s_add_u32 s54, s54, 131072
    buffer_load_dwordx4 v[40:43], v16, s[16:19], s55 offen
    s_add_u32 s55, s55, 1024
    v_mfma_f32_16x16x32_bf16 v[116:119], v[44:47], v[20:23], v[116:119]
    v_mfma_f32_16x16x32_bf16 v[120:123], v[44:47], v[24:27], v[120:123]
    v_mfma_f32_16x16x32_bf16 v[124:127], v[44:47], v[28:31], v[124:127]
    v_mfma_f32_16x16x32_bf16 v[128:131], v[44:47], v[32:35], v[128:131]
    buffer_load_dwordx4 v[44:47], v16, s[16:19], s56 offen
    s_add_u32 s56, s56, 1024
    v_mfma_f32_16x16x32_bf16 v[132:135], v[48:51], v[20:23], v[132:135]
    v_mfma_f32_16x16x32_bf16 v[136:139], v[48:51], v[24:27], v[136:139]
    v_mfma_f32_16x16x32_bf16 v[140:143], v[48:51], v[28:31], v[140:143]
    v_mfma_f32_16x16x32_bf16 v[144:147], v[48:51], v[32:35], v[144:147]
    buffer_load_dwordx4 v[48:51], v16, s[16:19], s57 offen
    s_add_u32 s57, s57, 1024
    v_mfma_f32_16x16x32_bf16 v[148:151], v[52:55], v[20:23], v[148:151]
    v_mfma_f32_16x16x32_bf16 v[152:155], v[52:55], v[24:27], v[152:155]
    v_mfma_f32_16x16x32_bf16 v[156:159], v[52:55], v[28:31], v[156:159]
    v_mfma_f32_16x16x32_bf16 v[160:163], v[52:55], v[32:35], v[160:163]
    buffer_load_dwordx4 v[52:55], v16, s[16:19], s58 offen
    s_add_u32 s58, s58, 1024
    v_mfma_f32_16x16x32_bf16 v[164:167], v[56:59], v[20:23], v[164:167]
    v_mfma_f32_16x16x32_bf16 v[168:171], v[56:59], v[24:27], v[168:171]
    v_mfma_f32_16x16x32_bf16 v[172:175], v[56:59], v[28:31], v[172:175]
    v_mfma_f32_16x16x32_bf16 v[176:179], v[56:59], v[32:35], v[176:179]
    buffer_load_dwordx4 v[56:59], v16, s[16:19], s59 offen
    s_add_u32 s59, s59, 1024
    s_waitcnt vmcnt(18)
    ds_write_b128 v17, v[196:199] offset:0
    ds_write_b128 v17, v[200:203] offset:1024
    ds_write_b128 v17, v[204:207] offset:2048
    ds_write_b128 v17, v[208:211] offset:3072
    s_waitcnt lgkmcnt(0)
    ds_read_b64_tr_b16 v[20:21], v10
    ds_read_b64_tr_b16 v[22:23], v10 offset:2048
    ds_read_b64_tr_b16 v[24:25], v11
    ds_read_b64_tr_b16 v[26:27], v11 offset:2048
    ds_read_b64_tr_b16 v[28:29], v12
    ds_read_b64_tr_b16 v[30:31], v12 offset:2048
    ds_read_b64_tr_b16 v[32:33], v13
    ds_read_b64_tr_b16 v[34:35], v13 offset:2048
    s_waitcnt lgkmcnt(0)
    v_mfma_f32_16x16x32_bf16 v[100:103], v[60:63], v[20:23], v[100:103]
    s_add_u32 s61, s54, 0
    buffer_load_dwordx4 v[196:199], v14, s[12:15], s61 offen
    v_mfma_f32_16x16x32_bf16 v[104:107], v[60:63], v[24:27], v[104:107]
    s_add_u32 s61, s54, 32768
    buffer_load_dwordx4 v[200:203], v14, s[12:15], s61 offen
    v_mfma_f32_16x16x32_bf16 v[108:111], v[60:63], v[28:31], v[108:111]
    s_add_u32 s61, s54, 65536
    buffer_load_dwordx4 v[204:207], v14, s[12:15], s61 offen
    v_mfma_f32_16x16x32_bf16 v[112:115], v[60:63], v[32:35], v[112:115]
    s_add_u32 s61, s54, 98304
    buffer_load_dwordx4 v[208:211], v14, s[12:15], s61 offen
    s_add_u32 s54, s54, 131072
    buffer_load_dwordx4 v[60:63], v16, s[16:19], s55 offen
    s_add_u32 s55, s55, 1024
    v_mfma_f32_16x16x32_bf16 v[116:119], v[64:67], v[20:23], v[116:119]
    v_mfma_f32_16x16x32_bf16 v[120:123], v[64:67], v[24:27], v[120:123]
    v_mfma_f32_16x16x32_bf16 v[124:127], v[64:67], v[28:31], v[124:127]
    v_mfma_f32_16x16x32_bf16 v[128:131], v[64:67], v[32:35], v[128:131]
    buffer_load_dwordx4 v[64:67], v16, s[16:19], s56 offen
    s_add_u32 s56, s56, 1024
    v_mfma_f32_16x16x32_bf16 v[132:135], v[68:71], v[20:23], v[132:135]
    v_mfma_f32_16x16x32_bf16 v[136:139], v[68:71], v[24:27], v[136:139]
    v_mfma_f32_16x16x32_bf16 v[140:143], v[68:71], v[28:31], v[140:143]
    v_mfma_f32_16x16x32_bf16 v[144:147], v[68:71], v[32:35], v[144:147]
    buffer_load_dwordx4 v[68:71], v16, s[16:19], s57 offen
    s_add_u32 s57, s57, 1024
    v_mfma_f32_16x16x32_bf16 v[148:151], v[72:75], v[20:23], v[148:151]
    v_mfma_f32_16x16x32_bf16 v[152:155], v[72:75], v[24:27], v[152:155]
    v_mfma_f32_16x16x32_bf16 v[156:159], v[72:75], v[28:31], v[156:159]
    v_mfma_f32_16x16x32_bf16 v[160:163], v[72:75], v[32:35], v[160:163]
    buffer_load_dwordx4 v[72:75], v16, s[16:19], s58 offen
    s_add_u32 s58, s58, 1024
    v_mfma_f32_16x16x32_bf16 v[164:167], v[76:79], v[20:23], v[164:167]
    v_mfma_f32_16x16x32_bf16 v[168:171], v[76:79], v[24:27], v[168:171]
    v_mfma_f32_16x16x32_bf16 v[172:175], v[76:79], v[28:31], v[172:175]
    v_mfma_f32_16x16x32_bf16 v[176:179], v[76:79], v[32:35], v[176:179]
    buffer_load_dwordx4 v[76:79], v16, s[16:19], s59 offen
    s_add_u32 s59, s59, 1024
    s_waitcnt vmcnt(18)
    ds_write_b128 v17, v[212:215] offset:0
    ds_write_b128 v17, v[216:219] offset:1024
    ds_write_b128 v17, v[220:223] offset:2048
    ds_write_b128 v17, v[224:227] offset:3072
    s_waitcnt lgkmcnt(0)
    ds_read_b64_tr_b16 v[20:21], v10
    ds_read_b64_tr_b16 v[22:23], v10 offset:2048
    ds_read_b64_tr_b16 v[24:25], v11
    ds_read_b64_tr_b16 v[26:27], v11 offset:2048
    ds_read_b64_tr_b16 v[28:29], v12
    ds_read_b64_tr_b16 v[30:31], v12 offset:2048
    ds_read_b64_tr_b16 v[32:33], v13
    ds_read_b64_tr_b16 v[34:35], v13 offset:2048
    s_waitcnt lgkmcnt(0)
    v_mfma_f32_16x16x32_bf16 v[100:103], v[80:83], v[20:23], v[100:103]
    s_add_u32 s61, s54, 0
    buffer_load_dwordx4 v[212:215], v14, s[12:15], s61 offen
    v_mfma_f32_16x16x32_bf16 v[104:107], v[80:83], v[24:27], v[104:107]
    s_add_u32 s61, s54, 32768
    buffer_load_dwordx4 v[216:219], v14, s[12:15], s61 offen
    v_mfma_f32_16x16x32_bf16 v[108:111], v[80:83], v[28:31], v[108:111]
    s_add_u32 s61, s54, 65536
    buffer_load_dwordx4 v[220:223], v14, s[12:15], s61 offen
    v_mfma_f32_16x16x32_bf16 v[112:115], v[80:83], v[32:35], v[112:115]
    s_add_u32 s61, s54, 98304
    buffer_load_dwordx4 v[224:227], v14, s[12:15], s61 offen
    s_add_u32 s54, s54, 131072
    buffer_load_dwordx4 v[80:83], v16, s[16:19], s55 offen
    s_add_u32 s55, s55, 1024
    v_mfma_f32_16x16x32_bf16 v[116:119], v[84:87], v[20:23], v[116:119]
    v_mfma_f32_16x16x32_bf16 v[120:123], v[84:87], v[24:27], v[120:123]
    v_mfma_f32_16x16x32_bf16 v[124:127], v[84:87], v[28:31], v[124:127]
    v_mfma_f32_16x16x32_bf16 v[128:131], v[84:87], v[32:35], v[128:131]
    buffer_load_dwordx4 v[84:87], v16, s[16:19], s56 offen
    s_add_u32 s56, s56, 1024
    v_mfma_f32_16x16x32_bf16 v[132:135], v[88:91], v[20:23], v[132:135]
    v_mfma_f32_16x16x32_bf16 v[136:139], v[88:91], v[24:27], v[136:139]
    v_mfma_f32_16x16x32_bf16 v[140:143], v[88:91], v[28:31], v[140:143]
    v_mfma_f32_16x16x32_bf16 v[144:147], v[88:91], v[32:35], v[144:147]
    buffer_load_dwordx4 v[88:91], v16, s[16:19], s57 offen
    s_add_u32 s57, s57, 1024
    v_mfma_f32_16x16x32_bf16 v[148:151], v[92:95], v[20:23], v[148:151]
    v_mfma_f32_16x16x32_bf16 v[152:155], v[92:95], v[24:27], v[152:155]
    v_mfma_f32_16x16x32_bf16 v[156:159], v[92:95], v[28:31], v[156:159]
    v_mfma_f32_16x16x32_bf16 v[160:163], v[92:95], v[32:35], v[160:163]
    buffer_load_dwordx4 v[92:95], v16, s[16:19], s58 offen
    s_add_u32 s58, s58, 1024
    v_mfma_f32_16x16x32_bf16 v[164:167], v[96:99], v[20:23], v[164:167]
    v_mfma_f32_16x16x32_bf16 v[168:171], v[96:99], v[24:27], v[168:171]
    v_mfma_f32_16x16x32_bf16 v[172:175], v[96:99], v[28:31], v[172:175]
    v_mfma_f32_16x16x32_bf16 v[176:179], v[96:99], v[32:35], v[176:179]
    buffer_load_dwordx4 v[96:99], v16, s[16:19], s59 offen
    s_add_u32 s59, s59, 1024
    s_waitcnt vmcnt(18)
    ds_write_b128 v17, v[180:183] offset:0
    ds_write_b128 v17, v[184:187] offset:1024
    ds_write_b128 v17, v[188:191] offset:2048
    ds_write_b128 v17, v[192:195] offset:3072
    s_waitcnt lgkmcnt(0)
    ds_read_b64_tr_b16 v[20:21], v10
    ds_read_b64_tr_b16 v[22:23], v10 offset:2048
    ds_read_b64_tr_b16 v[24:25], v11
    ds_read_b64_tr_b16 v[26:27], v11 offset:2048
    ds_read_b64_tr_b16 v[28:29], v12
    ds_read_b64_tr_b16 v[30:31], v12 offset:2048
    ds_read_b64_tr_b16 v[32:33], v13
    ds_read_b64_tr_b16 v[34:35], v13 offset:2048
    s_waitcnt lgkmcnt(0)
    v_mfma_f32_16x16x32_bf16 v[100:103], v[40:43], v[20:23], v[100:103]
    s_add_u32 s61, s54, 0
    buffer_load_dwordx4 v[180:183], v14, s[12:15], s61 offen
    v_mfma_f32_16x16x32_bf16 v[104:107], v[40:43], v[24:27], v[104:107]
    s_add_u32 s61, s54, 32768
    buffer_load_dwordx4 v[184:187], v14, s[12:15], s61 offen
    v_mfma_f32_16x16x32_bf16 v[108:111], v[40:43], v[28:31], v[108:111]
    s_add_u32 s61, s54, 65536
    buffer_load_dwordx4 v[188:191], v14, s[12:15], s61 offen
    v_mfma_f32_16x16x32_bf16 v[112:115], v[40:43], v[32:35], v[112:115]
    s_add_u32 s61, s54, 98304
    buffer_load_dwordx4 v[192:195], v14, s[12:15], s61 offen
    s_add_u32 s54, s54, 131072
    buffer_load_dwordx4 v[40:43], v16, s[16:19], s55 offen
    s_add_u32 s55, s55, 1024
    v_mfma_f32_16x16x32_bf16 v[116:119], v[44:47], v[20:23], v[116:119]
    v_mfma_f32_16x16x32_bf16 v[120:123], v[44:47], v[24:27], v[120:123]
    v_mfma_f32_16x16x32_bf16 v[124:127], v[44:47], v[28:31], v[124:127]
    v_mfma_f32_16x16x32_bf16 v[128:131], v[44:47], v[32:35], v[128:131]
    buffer_load_dwordx4 v[44:47], v16, s[16:19], s56 offen
    s_add_u32 s56, s56, 1024
    v_mfma_f32_16x16x32_bf16 v[132:135], v[48:51], v[20:23], v[132:135]
    v_mfma_f32_16x16x32_bf16 v[136:139], v[48:51], v[24:27], v[136:139]
    v_mfma_f32_16x16x32_bf16 v[140:143], v[48:51], v[28:31], v[140:143]
    v_mfma_f32_16x16x32_bf16 v[144:147], v[48:51], v[32:35], v[144:147]
    buffer_load_dwordx4 v[48:51], v16, s[16:19], s57 offen
    s_add_u32 s57, s57, 1024
    v_mfma_f32_16x16x32_bf16 v[148:151], v[52:55], v[20:23], v[148:151]
    v_mfma_f32_16x16x32_bf16 v[152:155], v[52:55], v[24:27], v[152:155]
    v_mfma_f32_16x16x32_bf16 v[156:159], v[52:55], v[28:31], v[156:159]
    v_mfma_f32_16x16x32_bf16 v[160:163], v[52:55], v[32:35], v[160:163]
    buffer_load_dwordx4 v[52:55], v16, s[16:19], s58 offen
    s_add_u32 s58, s58, 1024
    v_mfma_f32_16x16x32_bf16 v[164:167], v[56:59], v[20:23], v[164:167]
    v_mfma_f32_16x16x32_bf16 v[168:171], v[56:59], v[24:27], v[168:171]
    v_mfma_f32_16x16x32_bf16 v[172:175], v[56:59], v[28:31], v[172:175]
    v_mfma_f32_16x16x32_bf16 v[176:179], v[56:59], v[32:35], v[176:179]
    buffer_load_dwordx4 v[56:59], v16, s[16:19], s59 offen
    s_add_u32 s59, s59, 1024
    s_waitcnt vmcnt(18)
    ds_write_b128 v17, v[196:199] offset:0
    ds_write_b128 v17, v[200:203] offset:1024
    ds_write_b128 v17, v[204:207] offset:2048
    ds_write_b128 v17, v[208:211] offset:3072
    s_waitcnt lgkmcnt(0)
    ds_read_b64_tr_b16 v[20:21], v10
    ds_read_b64_tr_b16 v[22:23], v10 offset:2048
    ds_read_b64_tr_b16 v[24:25], v11
    ds_read_b64_tr_b16 v[26:27], v11 offset:2048
    ds_read_b64_tr_b16 v[28:29], v12
    ds_read_b64_tr_b16 v[30:31], v12 offset:2048
    ds_read_b64_tr_b16 v[32:33], v13
    ds_read_b64_tr_b16 v[34:35], v13 offset:2048
    s_waitcnt lgkmcnt(0)
    v_mfma_f32_16x16x32_bf16 v[100:103], v[60:63], v[20:23], v[100:103]
    s_add_u32 s61, s54, 0
    buffer_load_dwordx4 v[196:199], v14, s[12:15], s61 offen
    v_mfma_f32_16x16x32_bf16 v[104:107], v[60:63], v[24:27], v[104:107]
    s_add_u32 s61, s54, 32768
    buffer_load_dwordx4 v[200:203], v14, s[12:15], s61 offen
    v_mfma_f32_16x16x32_bf16 v[108:111], v[60:63], v[28:31], v[108:111]
    s_add_u32 s61, s54, 65536
    buffer_load_dwordx4 v[204:207], v14, s[12:15], s61 offen
    v_mfma_f32_16x16x32_bf16 v[112:115], v[60:63], v[32:35], v[112:115]
    s_add_u32 s61, s54, 98304
    buffer_load_dwordx4 v[208:211], v14, s[12:15], s61 offen
    s_add_u32 s54, s54, 131072
    buffer_load_dwordx4 v[60:63], v16, s[16:19], s55 offen
    s_add_u32 s55, s55, 1024
    v_mfma_f32_16x16x32_bf16 v[116:119], v[64:67], v[20:23], v[116:119]
    v_mfma_f32_16x16x32_bf16 v[120:123], v[64:67], v[24:27], v[120:123]
    v_mfma_f32_16x16x32_bf16 v[124:127], v[64:67], v[28:31], v[124:127]
    v_mfma_f32_16x16x32_bf16 v[128:131], v[64:67], v[32:35], v[128:131]
    buffer_load_dwordx4 v[64:67], v16, s[16:19], s56 offen
    s_add_u32 s56, s56, 1024
    v_mfma_f32_16x16x32_bf16 v[132:135], v[68:71], v[20:23], v[132:135]
    v_mfma_f32_16x16x32_bf16 v[136:139], v[68:71], v[24:27], v[136:139]
    v_mfma_f32_16x16x32_bf16 v[140:143], v[68:71], v[28:31], v[140:143]
    v_mfma_f32_16x16x32_bf16 v[144:147], v[68:71], v[32:35], v[144:147]
    buffer_load_dwordx4 v[68:71], v16, s[16:19], s57 offen
    s_add_u32 s57, s57, 1024
    v_mfma_f32_16x16x32_bf16 v[148:151], v[72:75], v[20:23], v[148:151]
    v_mfma_f32_16x16x32_bf16 v[152:155], v[72:75], v[24:27], v[152:155]
    v_mfma_f32_16x16x32_bf16 v[156:159], v[72:75], v[28:31], v[156:159]
    v_mfma_f32_16x16x32_bf16 v[160:163], v[72:75], v[32:35], v[160:163]
    buffer_load_dwordx4 v[72:75], v16, s[16:19], s58 offen
    s_add_u32 s58, s58, 1024
    v_mfma_f32_16x16x32_bf16 v[164:167], v[76:79], v[20:23], v[164:167]
    v_mfma_f32_16x16x32_bf16 v[168:171], v[76:79], v[24:27], v[168:171]
    v_mfma_f32_16x16x32_bf16 v[172:175], v[76:79], v[28:31], v[172:175]
    v_mfma_f32_16x16x32_bf16 v[176:179], v[76:79], v[32:35], v[176:179]
    buffer_load_dwordx4 v[76:79], v16, s[16:19], s59 offen
    s_add_u32 s59, s59, 1024
    s_waitcnt vmcnt(18)
    ds_write_b128 v17, v[212:215] offset:0
    ds_write_b128 v17, v[216:219] offset:1024
    ds_write_b128 v17, v[220:223] offset:2048
    ds_write_b128 v17, v[224:227] offset:3072
    s_waitcnt lgkmcnt(0)
    ds_read_b64_tr_b16 v[20:21], v10
    ds_read_b64_tr_b16 v[22:23], v10 offset:2048
    ds_read_b64_tr_b16 v[24:25], v11
    ds_read_b64_tr_b16 v[26:27], v11 offset:2048
    ds_read_b64_tr_b16 v[28:29], v12
    ds_read_b64_tr_b16 v[30:31], v12 offset:2048
    ds_read_b64_tr_b16 v[32:33], v13
    ds_read_b64_tr_b16 v[34:35], v13 offset:2048
    s_waitcnt lgkmcnt(0)
    v_mfma_f32_16x16x32_bf16 v[100:103], v[80:83], v[20:23], v[100:103]
    s_add_u32 s61, s54, 0
    buffer_load_dwordx4 v[212:215], v14, s[12:15], s61 offen
    v_mfma_f32_16x16x32_bf16 v[104:107], v[80:83], v[24:27], v[104:107]
    s_add_u32 s61, s54, 32768
    buffer_load_dwordx4 v[216:219], v14, s[12:15], s61 offen
    v_mfma_f32_16x16x32_bf16 v[108:111], v[80:83], v[28:31], v[108:111]
    s_add_u32 s61, s54, 65536
    buffer_load_dwordx4 v[220:223], v14, s[12:15], s61 offen
    v_mfma_f32_16x16x32_bf16 v[112:115], v[80:83], v[32:35], v[112:115]
    s_add_u32 s61, s54, 98304
    buffer_load_dwordx4 v[224:227], v14, s[12:15], s61 offen
    s_add_u32 s54, s54, 131072
    buffer_load_dwordx4 v[80:83], v16, s[16:19], s55 offen
    s_add_u32 s55, s55, 1024
    v_mfma_f32_16x16x32_bf16 v[116:119], v[84:87], v[20:23], v[116:119]
    v_mfma_f32_16x16x32_bf16 v[120:123], v[84:87], v[24:27], v[120:123]
    v_mfma_f32_16x16x32_bf16 v[124:127], v[84:87], v[28:31], v[124:127]
    v_mfma_f32_16x16x32_bf16 v[128:131], v[84:87], v[32:35], v[128:131]
    buffer_load_dwordx4 v[84:87], v16, s[16:19], s56 offen
    s_add_u32 s56, s56, 1024
    v_mfma_f32_16x16x32_bf16 v[132:135], v[88:91], v[20:23], v[132:135]
    v_mfma_f32_16x16x32_bf16 v[136:139], v[88:91], v[24:27], v[136:139]
    v_mfma_f32_16x16x32_bf16 v[140:143], v[88:91], v[28:31], v[140:143]
    v_mfma_f32_16x16x32_bf16 v[144:147], v[88:91], v[32:35], v[144:147]
    buffer_load_dwordx4 v[88:91], v16, s[16:19], s57 offen
    s_add_u32 s57, s57, 1024
    v_mfma_f32_16x16x32_bf16 v[148:151], v[92:95], v[20:23], v[148:151]
    v_mfma_f32_16x16x32_bf16 v[152:155], v[92:95], v[24:27], v[152:155]
    v_mfma_f32_16x16x32_bf16 v[156:159], v[92:95], v[28:31], v[156:159]
    v_mfma_f32_16x16x32_bf16 v[160:163], v[92:95], v[32:35], v[160:163]
    buffer_load_dwordx4 v[92:95], v16, s[16:19], s58 offen
    s_add_u32 s58, s58, 1024
    v_mfma_f32_16x16x32_bf16 v[164:167], v[96:99], v[20:23], v[164:167]
    v_mfma_f32_16x16x32_bf16 v[168:171], v[96:99], v[24:27], v[168:171]
    v_mfma_f32_16x16x32_bf16 v[172:175], v[96:99], v[28:31], v[172:175]
    v_mfma_f32_16x16x32_bf16 v[176:179], v[96:99], v[32:35], v[176:179]
    buffer_load_dwordx4 v[96:99], v16, s[16:19], s59 offen
    s_add_u32 s59, s59, 1024
    s_waitcnt vmcnt(18)
    ds_write_b128 v17, v[180:183] offset:0
    ds_write_b128 v17, v[184:187] offset:1024
    ds_write_b128 v17, v[188:191] offset:2048
    ds_write_b128 v17, v[192:195] offset:3072
    s_waitcnt lgkmcnt(0)
    ds_read_b64_tr_b16 v[20:21], v10
    ds_read_b64_tr_b16 v[22:23], v10 offset:2048
    ds_read_b64_tr_b16 v[24:25], v11
    ds_read_b64_tr_b16 v[26:27], v11 offset:2048
    ds_read_b64_tr_b16 v[28:29], v12
    ds_read_b64_tr_b16 v[30:31], v12 offset:2048
    ds_read_b64_tr_b16 v[32:33], v13
    ds_read_b64_tr_b16 v[34:35], v13 offset:2048
    s_waitcnt lgkmcnt(0)
    v_mfma_f32_16x16x32_bf16 v[100:103], v[40:43], v[20:23], v[100:103]
    s_add_u32 s61, s54, 0
    buffer_load_dwordx4 v[180:183], v14, s[12:15], s61 offen
    v_mfma_f32_16x16x32_bf16 v[104:107], v[40:43], v[24:27], v[104:107]
    s_add_u32 s61, s54, 32768
    buffer_load_dwordx4 v[184:187], v14, s[12:15], s61 offen
    v_mfma_f32_16x16x32_bf16 v[108:111], v[40:43], v[28:31], v[108:111]
    s_add_u32 s61, s54, 65536
    buffer_load_dwordx4 v[188:191], v14, s[12:15], s61 offen
    v_mfma_f32_16x16x32_bf16 v[112:115], v[40:43], v[32:35], v[112:115]
    s_add_u32 s61, s54, 98304
    buffer_load_dwordx4 v[192:195], v14, s[12:15], s61 offen
    s_add_u32 s54, s54, 131072
    buffer_load_dwordx4 v[40:43], v16, s[16:19], s55 offen
    s_add_u32 s55, s55, 1024
    v_mfma_f32_16x16x32_bf16 v[116:119], v[44:47], v[20:23], v[116:119]
    v_mfma_f32_16x16x32_bf16 v[120:123], v[44:47], v[24:27], v[120:123]
    v_mfma_f32_16x16x32_bf16 v[124:127], v[44:47], v[28:31], v[124:127]
    v_mfma_f32_16x16x32_bf16 v[128:131], v[44:47], v[32:35], v[128:131]
    buffer_load_dwordx4 v[44:47], v16, s[16:19], s56 offen
    s_add_u32 s56, s56, 1024
    v_mfma_f32_16x16x32_bf16 v[132:135], v[48:51], v[20:23], v[132:135]
    v_mfma_f32_16x16x32_bf16 v[136:139], v[48:51], v[24:27], v[136:139]
    v_mfma_f32_16x16x32_bf16 v[140:143], v[48:51], v[28:31], v[140:143]
    v_mfma_f32_16x16x32_bf16 v[144:147], v[48:51], v[32:35], v[144:147]
    buffer_load_dwordx4 v[48:51], v16, s[16:19], s57 offen
    s_add_u32 s57, s57, 1024
    v_mfma_f32_16x16x32_bf16 v[148:151], v[52:55], v[20:23], v[148:151]
    v_mfma_f32_16x16x32_bf16 v[152:155], v[52:55], v[24:27], v[152:155]
    v_mfma_f32_16x16x32_bf16 v[156:159], v[52:55], v[28:31], v[156:159]
    v_mfma_f32_16x16x32_bf16 v[160:163], v[52:55], v[32:35], v[160:163]
    buffer_load_dwordx4 v[52:55], v16, s[16:19], s58 offen
    s_add_u32 s58, s58, 1024
    v_mfma_f32_16x16x32_bf16 v[164:167], v[56:59], v[20:23], v[164:167]
    v_mfma_f32_16x16x32_bf16 v[168:171], v[56:59], v[24:27], v[168:171]
    v_mfma_f32_16x16x32_bf16 v[172:175], v[56:59], v[28:31], v[172:175]
    v_mfma_f32_16x16x32_bf16 v[176:179], v[56:59], v[32:35], v[176:179]
    buffer_load_dwordx4 v[56:59], v16, s[16:19], s59 offen
    s_add_u32 s59, s59, 1024
    s_waitcnt vmcnt(18)
    ds_write_b128 v17, v[196:199] offset:0
    ds_write_b128 v17, v[200:203] offset:1024
    ds_write_b128 v17, v[204:207] offset:2048
    ds_write_b128 v17, v[208:211] offset:3072
    s_waitcnt lgkmcnt(0)
    ds_read_b64_tr_b16 v[20:21], v10
    ds_read_b64_tr_b16 v[22:23], v10 offset:2048
    ds_read_b64_tr_b16 v[24:25], v11
    ds_read_b64_tr_b16 v[26:27], v11 offset:2048
    ds_read_b64_tr_b16 v[28:29], v12
    ds_read_b64_tr_b16 v[30:31], v12 offset:2048
    ds_read_b64_tr_b16 v[32:33], v13
    ds_read_b64_tr_b16 v[34:35], v13 offset:2048
    s_waitcnt lgkmcnt(0)
    v_mfma_f32_16x16x32_bf16 v[100:103], v[60:63], v[20:23], v[100:103]
    s_add_u32 s61, s54, 0
    buffer_load_dwordx4 v[196:199], v14, s[12:15], s61 offen
    v_mfma_f32_16x16x32_bf16 v[104:107], v[60:63], v[24:27], v[104:107]
    s_add_u32 s61, s54, 32768
    buffer_load_dwordx4 v[200:203], v14, s[12:15], s61 offen
    v_mfma_f32_16x16x32_bf16 v[108:111], v[60:63], v[28:31], v[108:111]
    s_add_u32 s61, s54, 65536
    buffer_load_dwordx4 v[204:207], v14, s[12:15], s61 offen
    v_mfma_f32_16x16x32_bf16 v[112:115], v[60:63], v[32:35], v[112:115]
    s_add_u32 s61, s54, 98304
    buffer_load_dwordx4 v[208:211], v14, s[12:15], s61 offen
    s_add_u32 s54, s54, 131072
    buffer_load_dwordx4 v[60:63], v16, s[16:19], s55 offen
    s_add_u32 s55, s55, 1024
    v_mfma_f32_16x16x32_bf16 v[116:119], v[64:67], v[20:23], v[116:119]
    v_mfma_f32_16x16x32_bf16 v[120:123], v[64:67], v[24:27], v[120:123]
    v_mfma_f32_16x16x32_bf16 v[124:127], v[64:67], v[28:31], v[124:127]
    v_mfma_f32_16x16x32_bf16 v[128:131], v[64:67], v[32:35], v[128:131]
    buffer_load_dwordx4 v[64:67], v16, s[16:19], s56 offen
    s_add_u32 s56, s56, 1024
    v_mfma_f32_16x16x32_bf16 v[132:135], v[68:71], v[20:23], v[132:135]
    v_mfma_f32_16x16x32_bf16 v[136:139], v[68:71], v[24:27], v[136:139]
    v_mfma_f32_16x16x32_bf16 v[140:143], v[68:71], v[28:31], v[140:143]
    v_mfma_f32_16x16x32_bf16 v[144:147], v[68:71], v[32:35], v[144:147]
    buffer_load_dwordx4 v[68:71], v16, s[16:19], s57 offen
    s_add_u32 s57, s57, 1024
    v_mfma_f32_16x16x32_bf16 v[148:151], v[72:75], v[20:23], v[148:151]
    v_mfma_f32_16x16x32_bf16 v[152:155], v[72:75], v[24:27], v[152:155]
    v_mfma_f32_16x16x32_bf16 v[156:159], v[72:75], v[28:31], v[156:159]
    v_mfma_f32_16x16x32_bf16 v[160:163], v[72:75], v[32:35], v[160:163]
    buffer_load_dwordx4 v[72:75], v16, s[16:19], s58 offen
    s_add_u32 s58, s58, 1024
    v_mfma_f32_16x16x32_bf16 v[164:167], v[76:79], v[20:23], v[164:167]
    v_mfma_f32_16x16x32_bf16 v[168:171], v[76:79], v[24:27], v[168:171]
    v_mfma_f32_16x16x32_bf16 v[172:175], v[76:79], v[28:31], v[172:175]
    v_mfma_f32_16x16x32_bf16 v[176:179], v[76:79], v[32:35], v[176:179]
    buffer_load_dwordx4 v[76:79], v16, s[16:19], s59 offen
    s_add_u32 s59, s59, 1024
    s_waitcnt vmcnt(18)
    ds_write_b128 v17, v[212:215] offset:0
    ds_write_b128 v17, v[216:219] offset:1024
    ds_write_b128 v17, v[220:223] offset:2048
    ds_write_b128 v17, v[224:227] offset:3072
    s_waitcnt lgkmcnt(0)
    ds_read_b64_tr_b16 v[20:21], v10
    ds_read_b64_tr_b16 v[22:23], v10 offset:2048
    ds_read_b64_tr_b16 v[24:25], v11
    ds_read_b64_tr_b16 v[26:27], v11 offset:2048
    ds_read_b64_tr_b16 v[28:29], v12
    ds_read_b64_tr_b16 v[30:31], v12 offset:2048
    ds_read_b64_tr_b16 v[32:33], v13
    ds_read_b64_tr_b16 v[34:35], v13 offset:2048
    s_waitcnt lgkmcnt(0)
    v_mfma_f32_16x16x32_bf16 v[100:103], v[80:83], v[20:23], v[100:103]
    s_add_u32 s61, s54, 0
    buffer_load_dwordx4 v[212:215], v14, s[12:15], s61 offen
    v_mfma_f32_16x16x32_bf16 v[104:107], v[80:83], v[24:27], v[104:107]
    s_add_u32 s61, s54, 32768
    buffer_load_dwordx4 v[216:219], v14, s[12:15], s61 offen
    v_mfma_f32_16x16x32_bf16 v[108:111], v[80:83], v[28:31], v[108:111]
    s_add_u32 s61, s54, 65536
    buffer_load_dwordx4 v[220:223], v14, s[12:15], s61 offen
    v_mfma_f32_16x16x32_bf16 v[112:115], v[80:83], v[32:35], v[112:115]
    s_add_u32 s61, s54, 98304
    buffer_load_dwordx4 v[224:227], v14, s[12:15], s61 offen
    s_add_u32 s54, s54, 131072
    buffer_load_dwordx4 v[80:83], v16, s[16:19], s55 offen
    s_add_u32 s55, s55, 1024
    v_mfma_f32_16x16x32_bf16 v[116:119], v[84:87], v[20:23], v[116:119]
    v_mfma_f32_16x16x32_bf16 v[120:123], v[84:87], v[24:27], v[120:123]
    v_mfma_f32_16x16x32_bf16 v[124:127], v[84:87], v[28:31], v[124:127]
    v_mfma_f32_16x16x32_bf16 v[128:131], v[84:87], v[32:35], v[128:131]
    buffer_load_dwordx4 v[84:87], v16, s[16:19], s56 offen
    s_add_u32 s56, s56, 1024
    v_mfma_f32_16x16x32_bf16 v[132:135], v[88:91], v[20:23], v[132:135]
    v_mfma_f32_16x16x32_bf16 v[136:139], v[88:91], v[24:27], v[136:139]
    v_mfma_f32_16x16x32_bf16 v[140:143], v[88:91], v[28:31], v[140:143]
    v_mfma_f32_16x16x32_bf16 v[144:147], v[88:91], v[32:35], v[144:147]
    buffer_load_dwordx4 v[88:91], v16, s[16:19], s57 offen
    s_add_u32 s57, s57, 1024
    v_mfma_f32_16x16x32_bf16 v[148:151], v[92:95], v[20:23], v[148:151]
    v_mfma_f32_16x16x32_bf16 v[152:155], v[92:95], v[24:27], v[152:155]
    v_mfma_f32_16x16x32_bf16 v[156:159], v[92:95], v[28:31], v[156:159]
    v_mfma_f32_16x16x32_bf16 v[160:163], v[92:95], v[32:35], v[160:163]
    buffer_load_dwordx4 v[92:95], v16, s[16:19], s58 offen
    s_add_u32 s58, s58, 1024
    v_mfma_f32_16x16x32_bf16 v[164:167], v[96:99], v[20:23], v[164:167]
    v_mfma_f32_16x16x32_bf16 v[168:171], v[96:99], v[24:27], v[168:171]
    v_mfma_f32_16x16x32_bf16 v[172:175], v[96:99], v[28:31], v[172:175]
    v_mfma_f32_16x16x32_bf16 v[176:179], v[96:99], v[32:35], v[176:179]
    buffer_load_dwordx4 v[96:99], v16, s[16:19], s59 offen
    s_add_u32 s59, s59, 1024
    s_waitcnt vmcnt(18)
    ds_write_b128 v17, v[180:183] offset:0
    ds_write_b128 v17, v[184:187] offset:1024
    ds_write_b128 v17, v[188:191] offset:2048
    ds_write_b128 v17, v[192:195] offset:3072
    s_waitcnt lgkmcnt(0)
    ds_read_b64_tr_b16 v[20:21], v10
    ds_read_b64_tr_b16 v[22:23], v10 offset:2048
    ds_read_b64_tr_b16 v[24:25], v11
    ds_read_b64_tr_b16 v[26:27], v11 offset:2048
    ds_read_b64_tr_b16 v[28:29], v12
    ds_read_b64_tr_b16 v[30:31], v12 offset:2048
    ds_read_b64_tr_b16 v[32:33], v13
    ds_read_b64_tr_b16 v[34:35], v13 offset:2048
    s_waitcnt lgkmcnt(0)
    v_mfma_f32_16x16x32_bf16 v[100:103], v[40:43], v[20:23], v[100:103]
    s_add_u32 s61, s54, 0
    buffer_load_dwordx4 v[180:183], v14, s[12:15], s61 offen
    v_mfma_f32_16x16x32_bf16 v[104:107], v[40:43], v[24:27], v[104:107]
    s_add_u32 s61, s54, 32768
    buffer_load_dwordx4 v[184:187], v14, s[12:15], s61 offen
    v_mfma_f32_16x16x32_bf16 v[108:111], v[40:43], v[28:31], v[108:111]
    s_add_u32 s61, s54, 65536
    buffer_load_dwordx4 v[188:191], v14, s[12:15], s61 offen
    v_mfma_f32_16x16x32_bf16 v[112:115], v[40:43], v[32:35], v[112:115]
    s_add_u32 s61, s54, 98304
    buffer_load_dwordx4 v[192:195], v14, s[12:15], s61 offen
    s_add_u32 s54, s54, 131072
    buffer_load_dwordx4 v[40:43], v16, s[16:19], s55 offen
    s_add_u32 s55, s55, 1024
    v_mfma_f32_16x16x32_bf16 v[116:119], v[44:47], v[20:23], v[116:119]
    v_mfma_f32_16x16x32_bf16 v[120:123], v[44:47], v[24:27], v[120:123]
    v_mfma_f32_16x16x32_bf16 v[124:127], v[44:47], v[28:31], v[124:127]
    v_mfma_f32_16x16x32_bf16 v[128:131], v[44:47], v[32:35], v[128:131]
    buffer_load_dwordx4 v[44:47], v16, s[16:19], s56 offen
    s_add_u32 s56, s56, 1024
    v_mfma_f32_16x16x32_bf16 v[132:135], v[48:51], v[20:23], v[132:135]
    v_mfma_f32_16x16x32_bf16 v[136:139], v[48:51], v[24:27], v[136:139]
    v_mfma_f32_16x16x32_bf16 v[140:143], v[48:51], v[28:31], v[140:143]
    v_mfma_f32_16x16x32_bf16 v[144:147], v[48:51], v[32:35], v[144:147]
    buffer_load_dwordx4 v[48:51], v16, s[16:19], s57 offen
    s_add_u32 s57, s57, 1024
    v_mfma_f32_16x16x32_bf16 v[148:151], v[52:55], v[20:23], v[148:151]
    v_mfma_f32_16x16x32_bf16 v[152:155], v[52:55], v[24:27], v[152:155]
    v_mfma_f32_16x16x32_bf16 v[156:159], v[52:55], v[28:31], v[156:159]
    v_mfma_f32_16x16x32_bf16 v[160:163], v[52:55], v[32:35], v[160:163]
    buffer_load_dwordx4 v[52:55], v16, s[16:19], s58 offen
    s_add_u32 s58, s58, 1024
    v_mfma_f32_16x16x32_bf16 v[164:167], v[56:59], v[20:23], v[164:167]
    v_mfma_f32_16x16x32_bf16 v[168:171], v[56:59], v[24:27], v[168:171]
    v_mfma_f32_16x16x32_bf16 v[172:175], v[56:59], v[28:31], v[172:175]
    v_mfma_f32_16x16x32_bf16 v[176:179], v[56:59], v[32:35], v[176:179]
    buffer_load_dwordx4 v[56:59], v16, s[16:19], s59 offen
    s_add_u32 s59, s59, 1024
    s_waitcnt vmcnt(18)
    ds_write_b128 v17, v[196:199] offset:0
    ds_write_b128 v17, v[200:203] offset:1024
    ds_write_b128 v17, v[204:207] offset:2048
    ds_write_b128 v17, v[208:211] offset:3072
    s_waitcnt lgkmcnt(0)
    ds_read_b64_tr_b16 v[20:21], v10
    ds_read_b64_tr_b16 v[22:23], v10 offset:2048
    ds_read_b64_tr_b16 v[24:25], v11
    ds_read_b64_tr_b16 v[26:27], v11 offset:2048
    ds_read_b64_tr_b16 v[28:29], v12
    ds_read_b64_tr_b16 v[30:31], v12 offset:2048
    ds_read_b64_tr_b16 v[32:33], v13
    ds_read_b64_tr_b16 v[34:35], v13 offset:2048
    s_waitcnt lgkmcnt(0)
    v_mfma_f32_16x16x32_bf16 v[100:103], v[60:63], v[20:23], v[100:103]
    s_add_u32 s61, s54, 0
    buffer_load_dwordx4 v[196:199], v14, s[12:15], s61 offen
    v_mfma_f32_16x16x32_bf16 v[104:107], v[60:63], v[24:27], v[104:107]
    s_add_u32 s61, s54, 32768
    buffer_load_dwordx4 v[200:203], v14, s[12:15], s61 offen
    v_mfma_f32_16x16x32_bf16 v[108:111], v[60:63], v[28:31], v[108:111]
    s_add_u32 s61, s54, 65536
    buffer_load_dwordx4 v[204:207], v14, s[12:15], s61 offen
    v_mfma_f32_16x16x32_bf16 v[112:115], v[60:63], v[32:35], v[112:115]
    s_add_u32 s61, s54, 98304
    buffer_load_dwordx4 v[208:211], v14, s[12:15], s61 offen
    s_add_u32 s54, s54, 131072
    buffer_load_dwordx4 v[60:63], v16, s[16:19], s55 offen
    s_add_u32 s55, s55, 1024
    v_mfma_f32_16x16x32_bf16 v[116:119], v[64:67], v[20:23], v[116:119]
    v_mfma_f32_16x16x32_bf16 v[120:123], v[64:67], v[24:27], v[120:123]
    v_mfma_f32_16x16x32_bf16 v[124:127], v[64:67], v[28:31], v[124:127]
    v_mfma_f32_16x16x32_bf16 v[128:131], v[64:67], v[32:35], v[128:131]
    buffer_load_dwordx4 v[64:67], v16, s[16:19], s56 offen
    s_add_u32 s56, s56, 1024
    v_mfma_f32_16x16x32_bf16 v[132:135], v[68:71], v[20:23], v[132:135]
    v_mfma_f32_16x16x32_bf16 v[136:139], v[68:71], v[24:27], v[136:139]
    v_mfma_f32_16x16x32_bf16 v[140:143], v[68:71], v[28:31], v[140:143]
    v_mfma_f32_16x16x32_bf16 v[144:147], v[68:71], v[32:35], v[144:147]
    buffer_load_dwordx4 v[68:71], v16, s[16:19], s57 offen
    s_add_u32 s57, s57, 1024
    v_mfma_f32_16x16x32_bf16 v[148:151], v[72:75], v[20:23], v[148:151]
    v_mfma_f32_16x16x32_bf16 v[152:155], v[72:75], v[24:27], v[152:155]
    v_mfma_f32_16x16x32_bf16 v[156:159], v[72:75], v[28:31], v[156:159]
    v_mfma_f32_16x16x32_bf16 v[160:163], v[72:75], v[32:35], v[160:163]
    buffer_load_dwordx4 v[72:75], v16, s[16:19], s58 offen
    s_add_u32 s58, s58, 1024
    v_mfma_f32_16x16x32_bf16 v[164:167], v[76:79], v[20:23], v[164:167]
    v_mfma_f32_16x16x32_bf16 v[168:171], v[76:79], v[24:27], v[168:171]
    v_mfma_f32_16x16x32_bf16 v[172:175], v[76:79], v[28:31], v[172:175]
    v_mfma_f32_16x16x32_bf16 v[176:179], v[76:79], v[32:35], v[176:179]
    buffer_load_dwordx4 v[76:79], v16, s[16:19], s59 offen
    s_add_u32 s59, s59, 1024
    s_waitcnt vmcnt(18)
    ds_write_b128 v17, v[212:215] offset:0
    ds_write_b128 v17, v[216:219] offset:1024
    ds_write_b128 v17, v[220:223] offset:2048
    ds_write_b128 v17, v[224:227] offset:3072
    s_waitcnt lgkmcnt(0)
    ds_read_b64_tr_b16 v[20:21], v10
    ds_read_b64_tr_b16 v[22:23], v10 offset:2048
    ds_read_b64_tr_b16 v[24:25], v11
    ds_read_b64_tr_b16 v[26:27], v11 offset:2048
    ds_read_b64_tr_b16 v[28:29], v12
    ds_read_b64_tr_b16 v[30:31], v12 offset:2048
    ds_read_b64_tr_b16 v[32:33], v13
    ds_read_b64_tr_b16 v[34:35], v13 offset:2048
    s_waitcnt lgkmcnt(0)
    v_mfma_f32_16x16x32_bf16 v[100:103], v[80:83], v[20:23], v[100:103]
    s_add_u32 s61, s54, 0
    buffer_load_dwordx4 v[212:215], v14, s[12:15], s61 offen
    v_mfma_f32_16x16x32_bf16 v[104:107], v[80:83], v[24:27], v[104:107]
    s_add_u32 s61, s54, 32768
    buffer_load_dwordx4 v[216:219], v14, s[12:15], s61 offen
    v_mfma_f32_16x16x32_bf16 v[108:111], v[80:83], v[28:31], v[108:111]
    s_add_u32 s61, s54, 65536
    buffer_load_dwordx4 v[220:223], v14, s[12:15], s61 offen
    v_mfma_f32_16x16x32_bf16 v[112:115], v[80:83], v[32:35], v[112:115]
    s_add_u32 s61, s54, 98304
    buffer_load_dwordx4 v[224:227], v14, s[12:15], s61 offen
    s_add_u32 s54, s54, 131072
    buffer_load_dwordx4 v[80:83], v16, s[16:19], s55 offen
    s_add_u32 s55, s55, 1024
    v_mfma_f32_16x16x32_bf16 v[116:119], v[84:87], v[20:23], v[116:119]
    v_mfma_f32_16x16x32_bf16 v[120:123], v[84:87], v[24:27], v[120:123]
    v_mfma_f32_16x16x32_bf16 v[124:127], v[84:87], v[28:31], v[124:127]
    v_mfma_f32_16x16x32_bf16 v[128:131], v[84:87], v[32:35], v[128:131]
    buffer_load_dwordx4 v[84:87], v16, s[16:19], s56 offen
    s_add_u32 s56, s56, 1024
    v_mfma_f32_16x16x32_bf16 v[132:135], v[88:91], v[20:23], v[132:135]
    v_mfma_f32_16x16x32_bf16 v[136:139], v[88:91], v[24:27], v[136:139]
    v_mfma_f32_16x16x32_bf16 v[140:143], v[88:91], v[28:31], v[140:143]
    v_mfma_f32_16x16x32_bf16 v[144:147], v[88:91], v[32:35], v[144:147]
    buffer_load_dwordx4 v[88:91], v16, s[16:19], s57 offen
    s_add_u32 s57, s57, 1024
    v_mfma_f32_16x16x32_bf16 v[148:151], v[92:95], v[20:23], v[148:151]
    v_mfma_f32_16x16x32_bf16 v[152:155], v[92:95], v[24:27], v[152:155]
    v_mfma_f32_16x16x32_bf16 v[156:159], v[92:95], v[28:31], v[156:159]
    v_mfma_f32_16x16x32_bf16 v[160:163], v[92:95], v[32:35], v[160:163]
    buffer_load_dwordx4 v[92:95], v16, s[16:19], s58 offen
    s_add_u32 s58, s58, 1024
    v_mfma_f32_16x16x32_bf16 v[164:167], v[96:99], v[20:23], v[164:167]
    v_mfma_f32_16x16x32_bf16 v[168:171], v[96:99], v[24:27], v[168:171]
    v_mfma_f32_16x16x32_bf16 v[172:175], v[96:99], v[28:31], v[172:175]
    v_mfma_f32_16x16x32_bf16 v[176:179], v[96:99], v[32:35], v[176:179]
    buffer_load_dwordx4 v[96:99], v16, s[16:19], s59 offen
    s_add_u32 s59, s59, 1024
    s_waitcnt vmcnt(18)
    ds_write_b128 v17, v[180:183] offset:0
    ds_write_b128 v17, v[184:187] offset:1024
    ds_write_b128 v17, v[188:191] offset:2048
    ds_write_b128 v17, v[192:195] offset:3072
    s_waitcnt lgkmcnt(0)
    ds_read_b64_tr_b16 v[20:21], v10
    ds_read_b64_tr_b16 v[22:23], v10 offset:2048
    ds_read_b64_tr_b16 v[24:25], v11
    ds_read_b64_tr_b16 v[26:27], v11 offset:2048
    ds_read_b64_tr_b16 v[28:29], v12
    ds_read_b64_tr_b16 v[30:31], v12 offset:2048
    ds_read_b64_tr_b16 v[32:33], v13
    ds_read_b64_tr_b16 v[34:35], v13 offset:2048
    s_waitcnt lgkmcnt(0)
    v_mfma_f32_16x16x32_bf16 v[100:103], v[40:43], v[20:23], v[100:103]
    s_add_u32 s61, s54, 0
    buffer_load_dwordx4 v[180:183], v14, s[12:15], s61 offen
    v_mfma_f32_16x16x32_bf16 v[104:107], v[40:43], v[24:27], v[104:107]
    s_add_u32 s61, s54, 32768
    buffer_load_dwordx4 v[184:187], v14, s[12:15], s61 offen
    v_mfma_f32_16x16x32_bf16 v[108:111], v[40:43], v[28:31], v[108:111]
    s_add_u32 s61, s54, 65536
    buffer_load_dwordx4 v[188:191], v14, s[12:15], s61 offen
    v_mfma_f32_16x16x32_bf16 v[112:115], v[40:43], v[32:35], v[112:115]
    s_add_u32 s61, s54, 98304
    buffer_load_dwordx4 v[192:195], v14, s[12:15], s61 offen
    s_add_u32 s54, s54, 131072
    buffer_load_dwordx4 v[40:43], v16, s[16:19], s55 offen
    s_add_u32 s55, s55, 1024
    v_mfma_f32_16x16x32_bf16 v[116:119], v[44:47], v[20:23], v[116:119]
    v_mfma_f32_16x16x32_bf16 v[120:123], v[44:47], v[24:27], v[120:123]
    v_mfma_f32_16x16x32_bf16 v[124:127], v[44:47], v[28:31], v[124:127]
    v_mfma_f32_16x16x32_bf16 v[128:131], v[44:47], v[32:35], v[128:131]
    buffer_load_dwordx4 v[44:47], v16, s[16:19], s56 offen
    s_add_u32 s56, s56, 1024
    v_mfma_f32_16x16x32_bf16 v[132:135], v[48:51], v[20:23], v[132:135]
    v_mfma_f32_16x16x32_bf16 v[136:139], v[48:51], v[24:27], v[136:139]
    v_mfma_f32_16x16x32_bf16 v[140:143], v[48:51], v[28:31], v[140:143]
    v_mfma_f32_16x16x32_bf16 v[144:147], v[48:51], v[32:35], v[144:147]
    buffer_load_dwordx4 v[48:51], v16, s[16:19], s57 offen
    s_add_u32 s57, s57, 1024
    v_mfma_f32_16x16x32_bf16 v[148:151], v[52:55], v[20:23], v[148:151]
    v_mfma_f32_16x16x32_bf16 v[152:155], v[52:55], v[24:27], v[152:155]
    v_mfma_f32_16x16x32_bf16 v[156:159], v[52:55], v[28:31], v[156:159]
    v_mfma_f32_16x16x32_bf16 v[160:163], v[52:55], v[32:35], v[160:163]
    buffer_load_dwordx4 v[52:55], v16, s[16:19], s58 offen
    s_add_u32 s58, s58, 1024
    v_mfma_f32_16x16x32_bf16 v[164:167], v[56:59], v[20:23], v[164:167]
    v_mfma_f32_16x16x32_bf16 v[168:171], v[56:59], v[24:27], v[168:171]
    v_mfma_f32_16x16x32_bf16 v[172:175], v[56:59], v[28:31], v[172:175]
    v_mfma_f32_16x16x32_bf16 v[176:179], v[56:59], v[32:35], v[176:179]
    buffer_load_dwordx4 v[56:59], v16, s[16:19], s59 offen
    s_add_u32 s59, s59, 1024
    s_waitcnt vmcnt(18)
    ds_write_b128 v17, v[196:199] offset:0
    ds_write_b128 v17, v[200:203] offset:1024
    ds_write_b128 v17, v[204:207] offset:2048
    ds_write_b128 v17, v[208:211] offset:3072
    s_waitcnt lgkmcnt(0)
    ds_read_b64_tr_b16 v[20:21], v10
    ds_read_b64_tr_b16 v[22:23], v10 offset:2048
    ds_read_b64_tr_b16 v[24:25], v11
    ds_read_b64_tr_b16 v[26:27], v11 offset:2048
    ds_read_b64_tr_b16 v[28:29], v12
    ds_read_b64_tr_b16 v[30:31], v12 offset:2048
    ds_read_b64_tr_b16 v[32:33], v13
    ds_read_b64_tr_b16 v[34:35], v13 offset:2048
    s_waitcnt lgkmcnt(0)
    v_mfma_f32_16x16x32_bf16 v[100:103], v[60:63], v[20:23], v[100:103]
    s_add_u32 s61, s54, 0
    buffer_load_dwordx4 v[196:199], v14, s[12:15], s61 offen
    v_mfma_f32_16x16x32_bf16 v[104:107], v[60:63], v[24:27], v[104:107]
    s_add_u32 s61, s54, 32768
    buffer_load_dwordx4 v[200:203], v14, s[12:15], s61 offen
    v_mfma_f32_16x16x32_bf16 v[108:111], v[60:63], v[28:31], v[108:111]
    s_add_u32 s61, s54, 65536
    buffer_load_dwordx4 v[204:207], v14, s[12:15], s61 offen
    v_mfma_f32_16x16x32_bf16 v[112:115], v[60:63], v[32:35], v[112:115]
    s_add_u32 s61, s54, 98304
    buffer_load_dwordx4 v[208:211], v14, s[12:15], s61 offen
    s_add_u32 s54, s54, 131072
    buffer_load_dwordx4 v[60:63], v16, s[16:19], s55 offen
    s_add_u32 s55, s55, 1024
    v_mfma_f32_16x16x32_bf16 v[116:119], v[64:67], v[20:23], v[116:119]
    v_mfma_f32_16x16x32_bf16 v[120:123], v[64:67], v[24:27], v[120:123]
    v_mfma_f32_16x16x32_bf16 v[124:127], v[64:67], v[28:31], v[124:127]
    v_mfma_f32_16x16x32_bf16 v[128:131], v[64:67], v[32:35], v[128:131]
    buffer_load_dwordx4 v[64:67], v16, s[16:19], s56 offen
    s_add_u32 s56, s56, 1024
    v_mfma_f32_16x16x32_bf16 v[132:135], v[68:71], v[20:23], v[132:135]
    v_mfma_f32_16x16x32_bf16 v[136:139], v[68:71], v[24:27], v[136:139]
    v_mfma_f32_16x16x32_bf16 v[140:143], v[68:71], v[28:31], v[140:143]
    v_mfma_f32_16x16x32_bf16 v[144:147], v[68:71], v[32:35], v[144:147]
    buffer_load_dwordx4 v[68:71], v16, s[16:19], s57 offen
    s_add_u32 s57, s57, 1024
    v_mfma_f32_16x16x32_bf16 v[148:151], v[72:75], v[20:23], v[148:151]
    v_mfma_f32_16x16x32_bf16 v[152:155], v[72:75], v[24:27], v[152:155]
    v_mfma_f32_16x16x32_bf16 v[156:159], v[72:75], v[28:31], v[156:159]
    v_mfma_f32_16x16x32_bf16 v[160:163], v[72:75], v[32:35], v[160:163]
    buffer_load_dwordx4 v[72:75], v16, s[16:19], s58 offen
    s_add_u32 s58, s58, 1024
    v_mfma_f32_16x16x32_bf16 v[164:167], v[76:79], v[20:23], v[164:167]
    v_mfma_f32_16x16x32_bf16 v[168:171], v[76:79], v[24:27], v[168:171]
    v_mfma_f32_16x16x32_bf16 v[172:175], v[76:79], v[28:31], v[172:175]
    v_mfma_f32_16x16x32_bf16 v[176:179], v[76:79], v[32:35], v[176:179]
    buffer_load_dwordx4 v[76:79], v16, s[16:19], s59 offen
    s_add_u32 s59, s59, 1024
    s_waitcnt vmcnt(18)
    ds_write_b128 v17, v[212:215] offset:0
    ds_write_b128 v17, v[216:219] offset:1024
    ds_write_b128 v17, v[220:223] offset:2048
    ds_write_b128 v17, v[224:227] offset:3072
    s_waitcnt lgkmcnt(0)
    ds_read_b64_tr_b16 v[20:21], v10
    ds_read_b64_tr_b16 v[22:23], v10 offset:2048
    ds_read_b64_tr_b16 v[24:25], v11
    ds_read_b64_tr_b16 v[26:27], v11 offset:2048
    ds_read_b64_tr_b16 v[28:29], v12
    ds_read_b64_tr_b16 v[30:31], v12 offset:2048
    ds_read_b64_tr_b16 v[32:33], v13
    ds_read_b64_tr_b16 v[34:35], v13 offset:2048
    s_waitcnt lgkmcnt(0)
    v_mfma_f32_16x16x32_bf16 v[100:103], v[80:83], v[20:23], v[100:103]
    s_add_u32 s61, s54, 0
    buffer_load_dwordx4 v[212:215], v14, s[12:15], s61 offen
    v_mfma_f32_16x16x32_bf16 v[104:107], v[80:83], v[24:27], v[104:107]
    s_add_u32 s61, s54, 32768
    buffer_load_dwordx4 v[216:219], v14, s[12:15], s61 offen
    v_mfma_f32_16x16x32_bf16 v[108:111], v[80:83], v[28:31], v[108:111]
    s_add_u32 s61, s54, 65536
    buffer_load_dwordx4 v[220:223], v14, s[12:15], s61 offen
    v_mfma_f32_16x16x32_bf16 v[112:115], v[80:83], v[32:35], v[112:115]
    s_add_u32 s61, s54, 98304
    buffer_load_dwordx4 v[224:227], v14, s[12:15], s61 offen
    s_add_u32 s54, s54, 131072
    buffer_load_dwordx4 v[80:83], v16, s[16:19], s55 offen
    s_add_u32 s55, s55, 1024
    v_mfma_f32_16x16x32_bf16 v[116:119], v[84:87], v[20:23], v[116:119]
    v_mfma_f32_16x16x32_bf16 v[120:123], v[84:87], v[24:27], v[120:123]
    v_mfma_f32_16x16x32_bf16 v[124:127], v[84:87], v[28:31], v[124:127]
    v_mfma_f32_16x16x32_bf16 v[128:131], v[84:87], v[32:35], v[128:131]
    buffer_load_dwordx4 v[84:87], v16, s[16:19], s56 offen
    s_add_u32 s56, s56, 1024
    v_mfma_f32_16x16x32_bf16 v[132:135], v[88:91], v[20:23], v[132:135]
    v_mfma_f32_16x16x32_bf16 v[136:139], v[88:91], v[24:27], v[136:139]
    v_mfma_f32_16x16x32_bf16 v[140:143], v[88:91], v[28:31], v[140:143]
    v_mfma_f32_16x16x32_bf16 v[144:147], v[88:91], v[32:35], v[144:147]
    buffer_load_dwordx4 v[88:91], v16, s[16:19], s57 offen
    s_add_u32 s57, s57, 1024
    v_mfma_f32_16x16x32_bf16 v[148:151], v[92:95], v[20:23], v[148:151]
    v_mfma_f32_16x16x32_bf16 v[152:155], v[92:95], v[24:27], v[152:155]
    v_mfma_f32_16x16x32_bf16 v[156:159], v[92:95], v[28:31], v[156:159]
    v_mfma_f32_16x16x32_bf16 v[160:163], v[92:95], v[32:35], v[160:163]
    buffer_load_dwordx4 v[92:95], v16, s[16:19], s58 offen
    s_add_u32 s58, s58, 1024
    v_mfma_f32_16x16x32_bf16 v[164:167], v[96:99], v[20:23], v[164:167]
    v_mfma_f32_16x16x32_bf16 v[168:171], v[96:99], v[24:27], v[168:171]
    v_mfma_f32_16x16x32_bf16 v[172:175], v[96:99], v[28:31], v[172:175]
    v_mfma_f32_16x16x32_bf16 v[176:179], v[96:99], v[32:35], v[176:179]
    buffer_load_dwordx4 v[96:99], v16, s[16:19], s59 offen
    s_add_u32 s59, s59, 1024
    s_waitcnt vmcnt(18)
    ds_write_b128 v17, v[180:183] offset:0
    ds_write_b128 v17, v[184:187] offset:1024
    ds_write_b128 v17, v[188:191] offset:2048
    ds_write_b128 v17, v[192:195] offset:3072
    s_waitcnt lgkmcnt(0)
    ds_read_b64_tr_b16 v[20:21], v10
    ds_read_b64_tr_b16 v[22:23], v10 offset:2048
    ds_read_b64_tr_b16 v[24:25], v11
    ds_read_b64_tr_b16 v[26:27], v11 offset:2048
    ds_read_b64_tr_b16 v[28:29], v12
    ds_read_b64_tr_b16 v[30:31], v12 offset:2048
    ds_read_b64_tr_b16 v[32:33], v13
    ds_read_b64_tr_b16 v[34:35], v13 offset:2048
    s_waitcnt lgkmcnt(0)
    v_mfma_f32_16x16x32_bf16 v[100:103], v[40:43], v[20:23], v[100:103]
    v_mfma_f32_16x16x32_bf16 v[104:107], v[40:43], v[24:27], v[104:107]
    v_mfma_f32_16x16x32_bf16 v[108:111], v[40:43], v[28:31], v[108:111]
    v_mfma_f32_16x16x32_bf16 v[112:115], v[40:43], v[32:35], v[112:115]
    v_mfma_f32_16x16x32_bf16 v[116:119], v[44:47], v[20:23], v[116:119]
    v_mfma_f32_16x16x32_bf16 v[120:123], v[44:47], v[24:27], v[120:123]
    v_mfma_f32_16x16x32_bf16 v[124:127], v[44:47], v[28:31], v[124:127]
    v_mfma_f32_16x16x32_bf16 v[128:131], v[44:47], v[32:35], v[128:131]
    v_mfma_f32_16x16x32_bf16 v[132:135], v[48:51], v[20:23], v[132:135]
    v_mfma_f32_16x16x32_bf16 v[136:139], v[48:51], v[24:27], v[136:139]
    v_mfma_f32_16x16x32_bf16 v[140:143], v[48:51], v[28:31], v[140:143]
    v_mfma_f32_16x16x32_bf16 v[144:147], v[48:51], v[32:35], v[144:147]
    v_mfma_f32_16x16x32_bf16 v[148:151], v[52:55], v[20:23], v[148:151]
    v_mfma_f32_16x16x32_bf16 v[152:155], v[52:55], v[24:27], v[152:155]
    v_mfma_f32_16x16x32_bf16 v[156:159], v[52:55], v[28:31], v[156:159]
    v_mfma_f32_16x16x32_bf16 v[160:163], v[52:55], v[32:35], v[160:163]
    v_mfma_f32_16x16x32_bf16 v[164:167], v[56:59], v[20:23], v[164:167]
    v_mfma_f32_16x16x32_bf16 v[168:171], v[56:59], v[24:27], v[168:171]
    v_mfma_f32_16x16x32_bf16 v[172:175], v[56:59], v[28:31], v[172:175]
    v_mfma_f32_16x16x32_bf16 v[176:179], v[56:59], v[32:35], v[176:179]
    s_waitcnt vmcnt(9)
    ds_write_b128 v17, v[196:199] offset:0
    ds_write_b128 v17, v[200:203] offset:1024
    ds_write_b128 v17, v[204:207] offset:2048
    ds_write_b128 v17, v[208:211] offset:3072
    s_waitcnt lgkmcnt(0)
    ds_read_b64_tr_b16 v[20:21], v10
    ds_read_b64_tr_b16 v[22:23], v10 offset:2048
    ds_read_b64_tr_b16 v[24:25], v11
    ds_read_b64_tr_b16 v[26:27], v11 offset:2048
    ds_read_b64_tr_b16 v[28:29], v12
    ds_read_b64_tr_b16 v[30:31], v12 offset:2048
    ds_read_b64_tr_b16 v[32:33], v13
    ds_read_b64_tr_b16 v[34:35], v13 offset:2048
    s_waitcnt lgkmcnt(0)
    v_mfma_f32_16x16x32_bf16 v[100:103], v[60:63], v[20:23], v[100:103]
    v_mfma_f32_16x16x32_bf16 v[104:107], v[60:63], v[24:27], v[104:107]
    v_mfma_f32_16x16x32_bf16 v[108:111], v[60:63], v[28:31], v[108:111]
    v_mfma_f32_16x16x32_bf16 v[112:115], v[60:63], v[32:35], v[112:115]
    v_mfma_f32_16x16x32_bf16 v[116:119], v[64:67], v[20:23], v[116:119]
    v_mfma_f32_16x16x32_bf16 v[120:123], v[64:67], v[24:27], v[120:123]
    v_mfma_f32_16x16x32_bf16 v[124:127], v[64:67], v[28:31], v[124:127]
    v_mfma_f32_16x16x32_bf16 v[128:131], v[64:67], v[32:35], v[128:131]
    v_mfma_f32_16x16x32_bf16 v[132:135], v[68:71], v[20:23], v[132:135]
    v_mfma_f32_16x16x32_bf16 v[136:139], v[68:71], v[24:27], v[136:139]
    v_mfma_f32_16x16x32_bf16 v[140:143], v[68:71], v[28:31], v[140:143]
    v_mfma_f32_16x16x32_bf16 v[144:147], v[68:71], v[32:35], v[144:147]
    v_mfma_f32_16x16x32_bf16 v[148:151], v[72:75], v[20:23], v[148:151]
    v_mfma_f32_16x16x32_bf16 v[152:155], v[72:75], v[24:27], v[152:155]
    v_mfma_f32_16x16x32_bf16 v[156:159], v[72:75], v[28:31], v[156:159]
    v_mfma_f32_16x16x32_bf16 v[160:163], v[72:75], v[32:35], v[160:163]
    v_mfma_f32_16x16x32_bf16 v[164:167], v[76:79], v[20:23], v[164:167]
    v_mfma_f32_16x16x32_bf16 v[168:171], v[76:79], v[24:27], v[168:171]
    v_mfma_f32_16x16x32_bf16 v[172:175], v[76:79], v[28:31], v[172:175]
    v_mfma_f32_16x16x32_bf16 v[176:179], v[76:79], v[32:35], v[176:179]
    s_waitcnt vmcnt(0)
    ds_write_b128 v17, v[212:215] offset:0
    ds_write_b128 v17, v[216:219] offset:1024
    ds_write_b128 v17, v[220:223] offset:2048
    ds_write_b128 v17, v[224:227] offset:3072
    s_waitcnt lgkmcnt(0)
    ds_read_b64_tr_b16 v[20:21], v10
    ds_read_b64_tr_b16 v[22:23], v10 offset:2048
    ds_read_b64_tr_b16 v[24:25], v11
    ds_read_b64_tr_b16 v[26:27], v11 offset:2048
    ds_read_b64_tr_b16 v[28:29], v12
    ds_read_b64_tr_b16 v[30:31], v12 offset:2048
    ds_read_b64_tr_b16 v[32:33], v13
    ds_read_b64_tr_b16 v[34:35], v13 offset:2048
    s_waitcnt lgkmcnt(0)
    v_mfma_f32_16x16x32_bf16 v[100:103], v[80:83], v[20:23], v[100:103]
    v_mfma_f32_16x16x32_bf16 v[104:107], v[80:83], v[24:27], v[104:107]
    v_mfma_f32_16x16x32_bf16 v[108:111], v[80:83], v[28:31], v[108:111]
    v_mfma_f32_16x16x32_bf16 v[112:115], v[80:83], v[32:35], v[112:115]
    v_mfma_f32_16x16x32_bf16 v[116:119], v[84:87], v[20:23], v[116:119]
    v_mfma_f32_16x16x32_bf16 v[120:123], v[84:87], v[24:27], v[120:123]
    v_mfma_f32_16x16x32_bf16 v[124:127], v[84:87], v[28:31], v[124:127]
    v_mfma_f32_16x16x32_bf16 v[128:131], v[84:87], v[32:35], v[128:131]
    v_mfma_f32_16x16x32_bf16 v[132:135], v[88:91], v[20:23], v[132:135]
    v_mfma_f32_16x16x32_bf16 v[136:139], v[88:91], v[24:27], v[136:139]
    v_mfma_f32_16x16x32_bf16 v[140:143], v[88:91], v[28:31], v[140:143]
    v_mfma_f32_16x16x32_bf16 v[144:147], v[88:91], v[32:35], v[144:147]
    v_mfma_f32_16x16x32_bf16 v[148:151], v[92:95], v[20:23], v[148:151]
    v_mfma_f32_16x16x32_bf16 v[152:155], v[92:95], v[24:27], v[152:155]
    v_mfma_f32_16x16x32_bf16 v[156:159], v[92:95], v[28:31], v[156:159]
    v_mfma_f32_16x16x32_bf16 v[160:163], v[92:95], v[32:35], v[160:163]
    v_mfma_f32_16x16x32_bf16 v[164:167], v[96:99], v[20:23], v[164:167]
    v_mfma_f32_16x16x32_bf16 v[168:171], v[96:99], v[24:27], v[168:171]
    v_mfma_f32_16x16x32_bf16 v[172:175], v[96:99], v[28:31], v[172:175]
    v_mfma_f32_16x16x32_bf16 v[176:179], v[96:99], v[32:35], v[176:179]
    s_nop 7
    s_barrier
    s_and_b32 s61, s53, 3
    s_mul_i32 s61, s61, 20480
    s_add_u32 s61, s61, 0
    v_add_u32 v7, s61, v16
    s_cmp_lt_u32 s53, 4
    s_cbranch_scc1 F_LOW
    ds_write_b128 v7, v[100:103] offset:0
    ds_write_b128 v7, v[104:107] offset:1024
    ds_write_b128 v7, v[108:111] offset:2048
    ds_write_b128 v7, v[112:115] offset:3072
    ds_write_b128 v7, v[116:119] offset:4096
    ds_write_b128 v7, v[120:123] offset:5120
    ds_write_b128 v7, v[124:127] offset:6144
    ds_write_b128 v7, v[128:131] offset:7168
    ds_write_b128 v7, v[132:135] offset:8192
    ds_write_b128 v7, v[136:139] offset:9216
    ds_write_b128 v7, v[140:143] offset:10240
    ds_write_b128 v7, v[144:147] offset:11264
    ds_write_b128 v7, v[148:151] offset:12288
    ds_write_b128 v7, v[152:155] offset:13312
    ds_write_b128 v7, v[156:159] offset:14336
    ds_write_b128 v7, v[160:163] offset:15360
    ds_write_b128 v7, v[164:167] offset:16384
    ds_write_b128 v7, v[168:171] offset:17408
    ds_write_b128 v7, v[172:175] offset:18432
    ds_write_b128 v7, v[176:179] offset:19456
    s_waitcnt lgkmcnt(0)
    s_barrier
    s_endpgm
F_LOW:
    s_lshl_b32 s61, s51, 6
    s_lshl_b32 s62, s53, 4
    s_add_u32 s61, s61, s62
    v_add_u32 v6, s61, v15
    v_lshlrev_b32 v10, 2, v6
    buffer_load_dword v18, v10, s[24:27], 0 offen
    v_lshlrev_b32 v10, 1, v6
    buffer_load_ushort v19, v10, s[32:35], 0 offen
    s_lshl_b32 s62, s52, 4
    v_lshlrev_b32 v8, 2, v3
    v_add_u32 v8, s62, v8
    v_mul_u32_u24 v9, 576, v6
    v_add_u32 v9, v9, v8
    v_lshlrev_b32 v9, 1, v9
    v_lshlrev_b32 v8, 1, v8
    buffer_load_dwordx2 v[40:41], v9, s[44:47], 0 offen offset:0
    buffer_load_dwordx2 v[42:43], v8, s[28:31], 0 offen offset:0
    buffer_load_dwordx2 v[44:45], v9, s[44:47], 0 offen offset:32
    buffer_load_dwordx2 v[46:47], v8, s[28:31], 0 offen offset:32
    buffer_load_dwordx2 v[48:49], v9, s[44:47], 0 offen offset:64
    buffer_load_dwordx2 v[50:51], v8, s[28:31], 0 offen offset:64
    buffer_load_dwordx2 v[52:53], v9, s[44:47], 0 offen offset:96
    buffer_load_dwordx2 v[54:55], v8, s[28:31], 0 offen offset:96
    buffer_load_dwordx2 v[56:57], v9, s[44:47], 0 offen offset:128
    buffer_load_dwordx2 v[58:59], v8, s[28:31], 0 offen offset:128
    s_barrier
    ds_read_b128 v[60:63], v7 offset:0
    ds_read_b128 v[64:67], v7 offset:1024
    ds_read_b128 v[68:71], v7 offset:2048
    ds_read_b128 v[72:75], v7 offset:3072
    ds_read_b128 v[76:79], v7 offset:4096
    ds_read_b128 v[80:83], v7 offset:5120
    ds_read_b128 v[84:87], v7 offset:6144
    ds_read_b128 v[88:91], v7 offset:7168
    ds_read_b128 v[92:95], v7 offset:8192
    ds_read_b128 v[96:99], v7 offset:9216
    s_waitcnt lgkmcnt(9)
    v_add_f32 v100, v100, v60
    v_add_f32 v101, v101, v61
    v_add_f32 v102, v102, v62
    v_add_f32 v103, v103, v63
    s_waitcnt lgkmcnt(8)
    v_add_f32 v104, v104, v64
    v_add_f32 v105, v105, v65
    v_add_f32 v106, v106, v66
    v_add_f32 v107, v107, v67
    s_waitcnt lgkmcnt(7)
    v_add_f32 v108, v108, v68
    v_add_f32 v109, v109, v69
    v_add_f32 v110, v110, v70
    v_add_f32 v111, v111, v71
    s_waitcnt lgkmcnt(6)
    v_add_f32 v112, v112, v72
    v_add_f32 v113, v113, v73
    v_add_f32 v114, v114, v74
    v_add_f32 v115, v115, v75
    s_waitcnt lgkmcnt(5)
    v_add_f32 v116, v116, v76
    v_add_f32 v117, v117, v77
    v_add_f32 v118, v118, v78
    v_add_f32 v119, v119, v79
    s_waitcnt lgkmcnt(4)
    v_add_f32 v120, v120, v80
    v_add_f32 v121, v121, v81
    v_add_f32 v122, v122, v82
    v_add_f32 v123, v123, v83
    s_waitcnt lgkmcnt(3)
    v_add_f32 v124, v124, v84
    v_add_f32 v125, v125, v85
    v_add_f32 v126, v126, v86
    v_add_f32 v127, v127, v87
    s_waitcnt lgkmcnt(2)
    v_add_f32 v128, v128, v88
    v_add_f32 v129, v129, v89
    v_add_f32 v130, v130, v90
    v_add_f32 v131, v131, v91
    s_waitcnt lgkmcnt(1)
    v_add_f32 v132, v132, v92
    v_add_f32 v133, v133, v93
    v_add_f32 v134, v134, v94
    v_add_f32 v135, v135, v95
    s_waitcnt lgkmcnt(0)
    v_add_f32 v136, v136, v96
    v_add_f32 v137, v137, v97
    v_add_f32 v138, v138, v98
    v_add_f32 v139, v139, v99
    ds_read_b128 v[60:63], v7 offset:10240
    ds_read_b128 v[64:67], v7 offset:11264
    ds_read_b128 v[68:71], v7 offset:12288
    ds_read_b128 v[72:75], v7 offset:13312
    ds_read_b128 v[76:79], v7 offset:14336
    ds_read_b128 v[80:83], v7 offset:15360
    ds_read_b128 v[84:87], v7 offset:16384
    ds_read_b128 v[88:91], v7 offset:17408
    ds_read_b128 v[92:95], v7 offset:18432
    ds_read_b128 v[96:99], v7 offset:19456
    s_waitcnt lgkmcnt(9)
    v_add_f32 v140, v140, v60
    v_add_f32 v141, v141, v61
    v_add_f32 v142, v142, v62
    v_add_f32 v143, v143, v63
    s_waitcnt lgkmcnt(8)
    v_add_f32 v144, v144, v64
    v_add_f32 v145, v145, v65
    v_add_f32 v146, v146, v66
    v_add_f32 v147, v147, v67
    s_waitcnt lgkmcnt(7)
    v_add_f32 v148, v148, v68
    v_add_f32 v149, v149, v69
    v_add_f32 v150, v150, v70
    v_add_f32 v151, v151, v71
    s_waitcnt lgkmcnt(6)
    v_add_f32 v152, v152, v72
    v_add_f32 v153, v153, v73
    v_add_f32 v154, v154, v74
    v_add_f32 v155, v155, v75
    s_waitcnt lgkmcnt(5)
    v_add_f32 v156, v156, v76
    v_add_f32 v157, v157, v77
    v_add_f32 v158, v158, v78
    v_add_f32 v159, v159, v79
    s_waitcnt lgkmcnt(4)
    v_add_f32 v160, v160, v80
    v_add_f32 v161, v161, v81
    v_add_f32 v162, v162, v82
    v_add_f32 v163, v163, v83
    s_waitcnt lgkmcnt(3)
    v_add_f32 v164, v164, v84
    v_add_f32 v165, v165, v85
    v_add_f32 v166, v166, v86
    v_add_f32 v167, v167, v87
    s_waitcnt lgkmcnt(2)
    v_add_f32 v168, v168, v88
    v_add_f32 v169, v169, v89
    v_add_f32 v170, v170, v90
    v_add_f32 v171, v171, v91
    s_waitcnt lgkmcnt(1)
    v_add_f32 v172, v172, v92
    v_add_f32 v173, v173, v93
    v_add_f32 v174, v174, v94
    v_add_f32 v175, v175, v95
    s_waitcnt lgkmcnt(0)
    v_add_f32 v176, v176, v96
    v_add_f32 v177, v177, v97
    v_add_f32 v178, v178, v98
    v_add_f32 v179, v179, v99
    ds_write_b128 v7, v[100:103] offset:0
    ds_write_b128 v7, v[104:107] offset:1024
    ds_write_b128 v7, v[108:111] offset:2048
    ds_write_b128 v7, v[112:115] offset:3072
    ds_write_b128 v7, v[116:119] offset:4096
    ds_write_b128 v7, v[120:123] offset:5120
    ds_write_b128 v7, v[124:127] offset:6144
    ds_write_b128 v7, v[128:131] offset:7168
    ds_write_b128 v7, v[132:135] offset:8192
    ds_write_b128 v7, v[136:139] offset:9216
    ds_write_b128 v7, v[140:143] offset:10240
    ds_write_b128 v7, v[144:147] offset:11264
    ds_write_b128 v7, v[148:151] offset:12288
    ds_write_b128 v7, v[152:155] offset:13312
    ds_write_b128 v7, v[156:159] offset:14336
    ds_write_b128 v7, v[160:163] offset:15360
    ds_write_b128 v7, v[164:167] offset:16384
    ds_write_b128 v7, v[168:171] offset:17408
    ds_write_b128 v7, v[172:175] offset:18432
    ds_write_b128 v7, v[176:179] offset:19456
    s_waitcnt lgkmcnt(0)
    s_barrier
    s_lshl_b32 s61, s53, 10
    s_add_u32 s61, s61, 0
    v_add_u32 v7, s61, v16
    v_add_u32 v6, 40960, v7
    ds_read_b128 v[100:103], v7 offset:0
    ds_read_b128 v[104:107], v7 offset:20480
    ds_read_b128 v[108:111], v6 offset:0
    ds_read_b128 v[112:115], v6 offset:20480
    ds_read_b128 v[116:119], v7 offset:4096
    ds_read_b128 v[120:123], v7 offset:24576
    ds_read_b128 v[124:127], v6 offset:4096
    ds_read_b128 v[128:131], v6 offset:24576
    ds_read_b128 v[132:135], v7 offset:8192
    ds_read_b128 v[136:139], v7 offset:28672
    ds_read_b128 v[140:143], v6 offset:8192
    ds_read_b128 v[144:147], v6 offset:28672
    ds_read_b128 v[148:151], v7 offset:12288
    ds_read_b128 v[152:155], v7 offset:32768
    ds_read_b128 v[156:159], v6 offset:12288
    ds_read_b128 v[160:163], v6 offset:32768
    ds_read_b128 v[164:167], v7 offset:16384
    ds_read_b128 v[168:171], v7 offset:36864
    ds_read_b128 v[172:175], v6 offset:16384
    ds_read_b128 v[176:179], v6 offset:36864
    v_lshl_add_u32 v10, v3, 2, v4
    v_lshlrev_b32 v10, 7, v10
    v_lshl_add_u32 v10, v5, 3, v10
    s_lshl_b32 s61, s53, 5
    s_add_u32 s61, s61, 81920
    v_add_u32 v10, s61, v10
    s_waitcnt lgkmcnt(0)
    ds_read_b64_tr_b16 v[60:61], v10 offset:0
    ds_read_b64_tr_b16 v[62:63], v10 offset:2048
    ds_read_b64_tr_b16 v[64:65], v10 offset:4096
    ds_read_b64_tr_b16 v[66:67], v10 offset:6144
    ds_read_b64_tr_b16 v[68:69], v10 offset:8192
    s_mov_b32 s47, 0xffff0000
    s_waitcnt vmcnt(0) lgkmcnt(0)
    v_lshlrev_b32 v19, 16, v19
    v_sub_f32 v20, 1.0, v18
    v_cvt_pk_bf16_f32 v20, v20, v20
    v_lshlrev_b32 v20, 16, v20
    v_and_b32 v11, 1, v0
    v_add_f32 v100, v100, v104
    v_add_f32 v108, v108, v112
    v_add_f32 v100, v100, v108
    v_add_f32 v101, v101, v105
    v_add_f32 v109, v109, v113
    v_add_f32 v101, v101, v109
    v_add_f32 v102, v102, v106
    v_add_f32 v110, v110, v114
    v_add_f32 v102, v102, v110
    v_add_f32 v103, v103, v107
    v_add_f32 v111, v111, v115
    v_add_f32 v103, v103, v111
    v_cvt_pk_bf16_f32 v21, v100, v101
    v_lshlrev_b32 v22, 16, v21
    v_and_b32 v23, s47, v21
    v_add_f32 v22, v22, v19
    v_add_f32 v23, v23, v19
    v_cvt_pk_bf16_f32 v21, v22, v23
    v_lshlrev_b32 v22, 16, v21
    v_and_b32 v23, s47, v21
    v_mul_f32 v22, v22, v20
    v_mul_f32 v23, v23, v20
    v_cvt_pk_bf16_f32 v21, v22, v23
    v_lshlrev_b32 v22, 16, v21
    v_and_b32 v23, s47, v21
    v_lshlrev_b32 v24, 16, v40
    v_and_b32 v25, s47, v40
    v_lshlrev_b32 v26, 16, v42
    v_and_b32 v27, s47, v42
    v_mul_f32 v24, v24, v26
    v_mul_f32 v25, v25, v27
    v_cvt_pk_bf16_f32 v21, v24, v25
    v_lshlrev_b32 v24, 16, v21
    v_and_b32 v25, s47, v21
    v_lshlrev_b32 v26, 16, v60
    v_and_b32 v27, s47, v60
    v_add_f32 v24, v24, v26
    v_add_f32 v25, v25, v27
    v_cvt_pk_bf16_f32 v21, v24, v25
    v_lshlrev_b32 v24, 16, v21
    v_and_b32 v25, s47, v21
    v_mul_f32 v24, v24, v18
    v_mul_f32 v25, v25, v18
    v_cvt_pk_bf16_f32 v21, v24, v25
    v_lshlrev_b32 v24, 16, v21
    v_and_b32 v25, s47, v21
    v_add_f32 v22, v22, v24
    v_add_f32 v23, v23, v25
    v_cvt_pk_bf16_f32 v70, v22, v23
    v_cvt_pk_bf16_f32 v21, v102, v103
    v_lshlrev_b32 v22, 16, v21
    v_and_b32 v23, s47, v21
    v_add_f32 v22, v22, v19
    v_add_f32 v23, v23, v19
    v_cvt_pk_bf16_f32 v21, v22, v23
    v_lshlrev_b32 v22, 16, v21
    v_and_b32 v23, s47, v21
    v_mul_f32 v22, v22, v20
    v_mul_f32 v23, v23, v20
    v_cvt_pk_bf16_f32 v21, v22, v23
    v_lshlrev_b32 v22, 16, v21
    v_and_b32 v23, s47, v21
    v_lshlrev_b32 v24, 16, v41
    v_and_b32 v25, s47, v41
    v_lshlrev_b32 v26, 16, v43
    v_and_b32 v27, s47, v43
    v_mul_f32 v24, v24, v26
    v_mul_f32 v25, v25, v27
    v_cvt_pk_bf16_f32 v21, v24, v25
    v_lshlrev_b32 v24, 16, v21
    v_and_b32 v25, s47, v21
    v_lshlrev_b32 v26, 16, v61
    v_and_b32 v27, s47, v61
    v_add_f32 v24, v24, v26
    v_add_f32 v25, v25, v27
    v_cvt_pk_bf16_f32 v21, v24, v25
    v_lshlrev_b32 v24, 16, v21
    v_and_b32 v25, s47, v21
    v_mul_f32 v24, v24, v18
    v_mul_f32 v25, v25, v18
    v_cvt_pk_bf16_f32 v21, v24, v25
    v_lshlrev_b32 v24, 16, v21
    v_and_b32 v25, s47, v21
    v_add_f32 v22, v22, v24
    v_add_f32 v23, v23, v25
    v_cvt_pk_bf16_f32 v71, v22, v23
    v_add_f32 v116, v116, v120
    v_add_f32 v124, v124, v128
    v_add_f32 v116, v116, v124
    v_add_f32 v117, v117, v121
    v_add_f32 v125, v125, v129
    v_add_f32 v117, v117, v125
    v_add_f32 v118, v118, v122
    v_add_f32 v126, v126, v130
    v_add_f32 v118, v118, v126
    v_add_f32 v119, v119, v123
    v_add_f32 v127, v127, v131
    v_add_f32 v119, v119, v127
    v_cvt_pk_bf16_f32 v21, v116, v117
    v_lshlrev_b32 v22, 16, v21
    v_and_b32 v23, s47, v21
    v_add_f32 v22, v22, v19
    v_add_f32 v23, v23, v19
    v_cvt_pk_bf16_f32 v21, v22, v23
    v_lshlrev_b32 v22, 16, v21
    v_and_b32 v23, s47, v21
    v_mul_f32 v22, v22, v20
    v_mul_f32 v23, v23, v20
    v_cvt_pk_bf16_f32 v21, v22, v23
    v_lshlrev_b32 v22, 16, v21
    v_and_b32 v23, s47, v21
    v_lshlrev_b32 v24, 16, v44
    v_and_b32 v25, s47, v44
    v_lshlrev_b32 v26, 16, v46
    v_and_b32 v27, s47, v46
    v_mul_f32 v24, v24, v26
    v_mul_f32 v25, v25, v27
    v_cvt_pk_bf16_f32 v21, v24, v25
    v_lshlrev_b32 v24, 16, v21
    v_and_b32 v25, s47, v21
    v_lshlrev_b32 v26, 16, v62
    v_and_b32 v27, s47, v62
    v_add_f32 v24, v24, v26
    v_add_f32 v25, v25, v27
    v_cvt_pk_bf16_f32 v21, v24, v25
    v_lshlrev_b32 v24, 16, v21
    v_and_b32 v25, s47, v21
    v_mul_f32 v24, v24, v18
    v_mul_f32 v25, v25, v18
    v_cvt_pk_bf16_f32 v21, v24, v25
    v_lshlrev_b32 v24, 16, v21
    v_and_b32 v25, s47, v21
    v_add_f32 v22, v22, v24
    v_add_f32 v23, v23, v25
    v_cvt_pk_bf16_f32 v72, v22, v23
    v_cvt_pk_bf16_f32 v21, v118, v119
    v_lshlrev_b32 v22, 16, v21
    v_and_b32 v23, s47, v21
    v_add_f32 v22, v22, v19
    v_add_f32 v23, v23, v19
    v_cvt_pk_bf16_f32 v21, v22, v23
    v_lshlrev_b32 v22, 16, v21
    v_and_b32 v23, s47, v21
    v_mul_f32 v22, v22, v20
    v_mul_f32 v23, v23, v20
    v_cvt_pk_bf16_f32 v21, v22, v23
    v_lshlrev_b32 v22, 16, v21
    v_and_b32 v23, s47, v21
    v_lshlrev_b32 v24, 16, v45
    v_and_b32 v25, s47, v45
    v_lshlrev_b32 v26, 16, v47
    v_and_b32 v27, s47, v47
    v_mul_f32 v24, v24, v26
    v_mul_f32 v25, v25, v27
    v_cvt_pk_bf16_f32 v21, v24, v25
    v_lshlrev_b32 v24, 16, v21
    v_and_b32 v25, s47, v21
    v_lshlrev_b32 v26, 16, v63
    v_and_b32 v27, s47, v63
    v_add_f32 v24, v24, v26
    v_add_f32 v25, v25, v27
    v_cvt_pk_bf16_f32 v21, v24, v25
    v_lshlrev_b32 v24, 16, v21
    v_and_b32 v25, s47, v21
    v_mul_f32 v24, v24, v18
    v_mul_f32 v25, v25, v18
    v_cvt_pk_bf16_f32 v21, v24, v25
    v_lshlrev_b32 v24, 16, v21
    v_and_b32 v25, s47, v21
    v_add_f32 v22, v22, v24
    v_add_f32 v23, v23, v25
    v_cvt_pk_bf16_f32 v73, v22, v23
    v_add_f32 v132, v132, v136
    v_add_f32 v140, v140, v144
    v_add_f32 v132, v132, v140
    v_add_f32 v133, v133, v137
    v_add_f32 v141, v141, v145
    v_add_f32 v133, v133, v141
    v_add_f32 v134, v134, v138
    v_add_f32 v142, v142, v146
    v_add_f32 v134, v134, v142
    v_add_f32 v135, v135, v139
    v_add_f32 v143, v143, v147
    v_add_f32 v135, v135, v143
    v_cvt_pk_bf16_f32 v21, v132, v133
    v_lshlrev_b32 v22, 16, v21
    v_and_b32 v23, s47, v21
    v_add_f32 v22, v22, v19
    v_add_f32 v23, v23, v19
    v_cvt_pk_bf16_f32 v21, v22, v23
    v_lshlrev_b32 v22, 16, v21
    v_and_b32 v23, s47, v21
    v_mul_f32 v22, v22, v20
    v_mul_f32 v23, v23, v20
    v_cvt_pk_bf16_f32 v21, v22, v23
    v_lshlrev_b32 v22, 16, v21
    v_and_b32 v23, s47, v21
    v_lshlrev_b32 v24, 16, v48
    v_and_b32 v25, s47, v48
    v_lshlrev_b32 v26, 16, v50
    v_and_b32 v27, s47, v50
    v_mul_f32 v24, v24, v26
    v_mul_f32 v25, v25, v27
    v_cvt_pk_bf16_f32 v21, v24, v25
    v_lshlrev_b32 v24, 16, v21
    v_and_b32 v25, s47, v21
    v_lshlrev_b32 v26, 16, v64
    v_and_b32 v27, s47, v64
    v_add_f32 v24, v24, v26
    v_add_f32 v25, v25, v27
    v_cvt_pk_bf16_f32 v21, v24, v25
    v_lshlrev_b32 v24, 16, v21
    v_and_b32 v25, s47, v21
    v_mul_f32 v24, v24, v18
    v_mul_f32 v25, v25, v18
    v_cvt_pk_bf16_f32 v21, v24, v25
    v_lshlrev_b32 v24, 16, v21
    v_and_b32 v25, s47, v21
    v_add_f32 v22, v22, v24
    v_add_f32 v23, v23, v25
    v_cvt_pk_bf16_f32 v74, v22, v23
    v_cvt_pk_bf16_f32 v21, v134, v135
    v_lshlrev_b32 v22, 16, v21
    v_and_b32 v23, s47, v21
    v_add_f32 v22, v22, v19
    v_add_f32 v23, v23, v19
    v_cvt_pk_bf16_f32 v21, v22, v23
    v_lshlrev_b32 v22, 16, v21
    v_and_b32 v23, s47, v21
    v_mul_f32 v22, v22, v20
    v_mul_f32 v23, v23, v20
    v_cvt_pk_bf16_f32 v21, v22, v23
    v_lshlrev_b32 v22, 16, v21
    v_and_b32 v23, s47, v21
    v_lshlrev_b32 v24, 16, v49
    v_and_b32 v25, s47, v49
    v_lshlrev_b32 v26, 16, v51
    v_and_b32 v27, s47, v51
    v_mul_f32 v24, v24, v26
    v_mul_f32 v25, v25, v27
    v_cvt_pk_bf16_f32 v21, v24, v25
    v_lshlrev_b32 v24, 16, v21
    v_and_b32 v25, s47, v21
    v_lshlrev_b32 v26, 16, v65
    v_and_b32 v27, s47, v65
    v_add_f32 v24, v24, v26
    v_add_f32 v25, v25, v27
    v_cvt_pk_bf16_f32 v21, v24, v25
    v_lshlrev_b32 v24, 16, v21
    v_and_b32 v25, s47, v21
    v_mul_f32 v24, v24, v18
    v_mul_f32 v25, v25, v18
    v_cvt_pk_bf16_f32 v21, v24, v25
    v_lshlrev_b32 v24, 16, v21
    v_and_b32 v25, s47, v21
    v_add_f32 v22, v22, v24
    v_add_f32 v23, v23, v25
    v_cvt_pk_bf16_f32 v75, v22, v23
    v_add_f32 v148, v148, v152
    v_add_f32 v156, v156, v160
    v_add_f32 v148, v148, v156
    v_add_f32 v149, v149, v153
    v_add_f32 v157, v157, v161
    v_add_f32 v149, v149, v157
    v_add_f32 v150, v150, v154
    v_add_f32 v158, v158, v162
    v_add_f32 v150, v150, v158
    v_add_f32 v151, v151, v155
    v_add_f32 v159, v159, v163
    v_add_f32 v151, v151, v159
    v_cvt_pk_bf16_f32 v21, v148, v149
    v_lshlrev_b32 v22, 16, v21
    v_and_b32 v23, s47, v21
    v_add_f32 v22, v22, v19
    v_add_f32 v23, v23, v19
    v_cvt_pk_bf16_f32 v21, v22, v23
    v_lshlrev_b32 v22, 16, v21
    v_and_b32 v23, s47, v21
    v_mul_f32 v22, v22, v20
    v_mul_f32 v23, v23, v20
    v_cvt_pk_bf16_f32 v21, v22, v23
    v_lshlrev_b32 v22, 16, v21
    v_and_b32 v23, s47, v21
    v_lshlrev_b32 v24, 16, v52
    v_and_b32 v25, s47, v52
    v_lshlrev_b32 v26, 16, v54
    v_and_b32 v27, s47, v54
    v_mul_f32 v24, v24, v26
    v_mul_f32 v25, v25, v27
    v_cvt_pk_bf16_f32 v21, v24, v25
    v_lshlrev_b32 v24, 16, v21
    v_and_b32 v25, s47, v21
    v_lshlrev_b32 v26, 16, v66
    v_and_b32 v27, s47, v66
    v_add_f32 v24, v24, v26
    v_add_f32 v25, v25, v27
    v_cvt_pk_bf16_f32 v21, v24, v25
    v_lshlrev_b32 v24, 16, v21
    v_and_b32 v25, s47, v21
    v_mul_f32 v24, v24, v18
    v_mul_f32 v25, v25, v18
    v_cvt_pk_bf16_f32 v21, v24, v25
    v_lshlrev_b32 v24, 16, v21
    v_and_b32 v25, s47, v21
    v_add_f32 v22, v22, v24
    v_add_f32 v23, v23, v25
    v_cvt_pk_bf16_f32 v76, v22, v23
    v_cvt_pk_bf16_f32 v21, v150, v151
    v_lshlrev_b32 v22, 16, v21
    v_and_b32 v23, s47, v21
    v_add_f32 v22, v22, v19
    v_add_f32 v23, v23, v19
    v_cvt_pk_bf16_f32 v21, v22, v23
    v_lshlrev_b32 v22, 16, v21
    v_and_b32 v23, s47, v21
    v_mul_f32 v22, v22, v20
    v_mul_f32 v23, v23, v20
    v_cvt_pk_bf16_f32 v21, v22, v23
    v_lshlrev_b32 v22, 16, v21
    v_and_b32 v23, s47, v21
    v_lshlrev_b32 v24, 16, v53
    v_and_b32 v25, s47, v53
    v_lshlrev_b32 v26, 16, v55
    v_and_b32 v27, s47, v55
    v_mul_f32 v24, v24, v26
    v_mul_f32 v25, v25, v27
    v_cvt_pk_bf16_f32 v21, v24, v25
    v_lshlrev_b32 v24, 16, v21
    v_and_b32 v25, s47, v21
    v_lshlrev_b32 v26, 16, v67
    v_and_b32 v27, s47, v67
    v_add_f32 v24, v24, v26
    v_add_f32 v25, v25, v27
    v_cvt_pk_bf16_f32 v21, v24, v25
    v_lshlrev_b32 v24, 16, v21
    v_and_b32 v25, s47, v21
    v_mul_f32 v24, v24, v18
    v_mul_f32 v25, v25, v18
    v_cvt_pk_bf16_f32 v21, v24, v25
    v_lshlrev_b32 v24, 16, v21
    v_and_b32 v25, s47, v21
    v_add_f32 v22, v22, v24
    v_add_f32 v23, v23, v25
    v_cvt_pk_bf16_f32 v77, v22, v23
    v_add_f32 v164, v164, v168
    v_add_f32 v172, v172, v176
    v_add_f32 v164, v164, v172
    v_add_f32 v165, v165, v169
    v_add_f32 v173, v173, v177
    v_add_f32 v165, v165, v173
    v_add_f32 v166, v166, v170
    v_add_f32 v174, v174, v178
    v_add_f32 v166, v166, v174
    v_add_f32 v167, v167, v171
    v_add_f32 v175, v175, v179
    v_add_f32 v167, v167, v175
    v_cvt_pk_bf16_f32 v21, v164, v165
    v_lshlrev_b32 v22, 16, v21
    v_and_b32 v23, s47, v21
    v_add_f32 v22, v22, v19
    v_add_f32 v23, v23, v19
    v_cvt_pk_bf16_f32 v21, v22, v23
    v_lshlrev_b32 v22, 16, v21
    v_and_b32 v23, s47, v21
    v_mul_f32 v22, v22, v20
    v_mul_f32 v23, v23, v20
    v_cvt_pk_bf16_f32 v21, v22, v23
    v_lshlrev_b32 v22, 16, v21
    v_and_b32 v23, s47, v21
    v_lshlrev_b32 v24, 16, v56
    v_and_b32 v25, s47, v56
    v_lshlrev_b32 v26, 16, v58
    v_and_b32 v27, s47, v58
    v_mul_f32 v24, v24, v26
    v_mul_f32 v25, v25, v27
    v_cvt_pk_bf16_f32 v21, v24, v25
    v_lshlrev_b32 v24, 16, v21
    v_and_b32 v25, s47, v21
    v_lshlrev_b32 v26, 16, v68
    v_and_b32 v27, s47, v68
    v_add_f32 v24, v24, v26
    v_add_f32 v25, v25, v27
    v_cvt_pk_bf16_f32 v21, v24, v25
    v_lshlrev_b32 v24, 16, v21
    v_and_b32 v25, s47, v21
    v_mul_f32 v24, v24, v18
    v_mul_f32 v25, v25, v18
    v_cvt_pk_bf16_f32 v21, v24, v25
    v_lshlrev_b32 v24, 16, v21
    v_and_b32 v25, s47, v21
    v_add_f32 v22, v22, v24
    v_add_f32 v23, v23, v25
    v_cvt_pk_bf16_f32 v78, v22, v23
    v_cvt_pk_bf16_f32 v21, v166, v167
    v_lshlrev_b32 v22, 16, v21
    v_and_b32 v23, s47, v21
    v_add_f32 v22, v22, v19
    v_add_f32 v23, v23, v19
    v_cvt_pk_bf16_f32 v21, v22, v23
    v_lshlrev_b32 v22, 16, v21
    v_and_b32 v23, s47, v21
    v_mul_f32 v22, v22, v20
    v_mul_f32 v23, v23, v20
    v_cvt_pk_bf16_f32 v21, v22, v23
    v_lshlrev_b32 v22, 16, v21
    v_and_b32 v23, s47, v21
    v_lshlrev_b32 v24, 16, v57
    v_and_b32 v25, s47, v57
    v_lshlrev_b32 v26, 16, v59
    v_and_b32 v27, s47, v59
    v_mul_f32 v24, v24, v26
    v_mul_f32 v25, v25, v27
    v_cvt_pk_bf16_f32 v21, v24, v25
    v_lshlrev_b32 v24, 16, v21
    v_and_b32 v25, s47, v21
    v_lshlrev_b32 v26, 16, v69
    v_and_b32 v27, s47, v69
    v_add_f32 v24, v24, v26
    v_add_f32 v25, v25, v27
    v_cvt_pk_bf16_f32 v21, v24, v25
    v_lshlrev_b32 v24, 16, v21
    v_and_b32 v25, s47, v21
    v_mul_f32 v24, v24, v18
    v_mul_f32 v25, v25, v18
    v_cvt_pk_bf16_f32 v21, v24, v25
    v_lshlrev_b32 v24, 16, v21
    v_and_b32 v25, s47, v21
    v_add_f32 v22, v22, v24
    v_add_f32 v23, v23, v25
    v_cvt_pk_bf16_f32 v79, v22, v23
    buffer_store_dwordx2 v[72:73], v9, s[36:39], 0 offen offset:32
    buffer_store_dwordx2 v[74:75], v9, s[36:39], 0 offen offset:64
    buffer_store_dwordx2 v[76:77], v9, s[36:39], 0 offen offset:96
    s_and_b32 s61, s50, 1
    s_cmp_eq_u32 s61, 0
    s_cbranch_scc0 F_ODD
    buffer_store_dwordx2 v[70:71], v9, s[36:39], 0 offen
    v_cmp_gt_u32 vcc, 2, v3
    s_and_saveexec_b64 s[48:49], vcc
    buffer_store_dwordx2 v[78:79], v9, s[36:39], 0 offen offset:128
    s_endpgm
F_ODD:
    buffer_store_dwordx2 v[78:79], v9, s[36:39], 0 offen offset:128
    v_cmp_le_u32 vcc, 2, v3
    s_and_saveexec_b64 s[48:49], vcc
    buffer_store_dwordx2 v[70:71], v9, s[36:39], 0 offen
    s_endpgm
.section .rodata,"a"
.p2align 6
.amdhsa_kernel prep_kernel
  .amdhsa_next_free_vgpr 128
  .amdhsa_next_free_sgpr 102
  .amdhsa_accum_offset 128
  .amdhsa_group_segment_fixed_size 0
  .amdhsa_kernarg_size 128
  .amdhsa_user_sgpr_count 2
  .amdhsa_user_sgpr_kernarg_segment_ptr 1
  .amdhsa_system_sgpr_workgroup_id_x 1
.end_amdhsa_kernel
.p2align 6
.amdhsa_kernel gemm1_kernel
  .amdhsa_next_free_vgpr 128
  .amdhsa_next_free_sgpr 102
  .amdhsa_accum_offset 128
  .amdhsa_group_segment_fixed_size 0
  .amdhsa_kernarg_size 128
  .amdhsa_user_sgpr_count 2
  .amdhsa_user_sgpr_kernarg_segment_ptr 1
  .amdhsa_system_sgpr_workgroup_id_x 1
.end_amdhsa_kernel
.p2align 6
.amdhsa_kernel gated_mix__ssm_conv_s4d__mixer_token_mlp__prompt_kernel
  .amdhsa_next_free_vgpr 228
  .amdhsa_next_free_sgpr 102
  .amdhsa_accum_offset 228
  .amdhsa_group_segment_fixed_size 0
  .amdhsa_kernarg_size 128
  .amdhsa_user_sgpr_count 2
  .amdhsa_user_sgpr_kernarg_segment_ptr 1
  .amdhsa_system_sgpr_workgroup_id_x 1
.end_amdhsa_kernel
```
